```python
import torch

def _softmax(x, axis=-1):
    return torch.softmax(x, dim=axis)
def _gelu(x):
    return torch.nn.functional.gelu(x, approximate="tanh")
def _silu(x):
    return torch.nn.functional.silu(x)
def _sigmoid(x):
    return torch.sigmoid(x)
def _layernorm(x, axis=-1, eps=1e-5):
    m = x.mean(dim=axis, keepdim=True)
    v = x.var(dim=axis, keepdim=True, unbiased=False)
    return (x - m) / torch.sqrt(v + eps)
def _scatter_add(tgt, idx, src, axis=0):
    return tgt.clone().index_add_(axis, idx, src)
def _segment_sum(src, seg, n):
    out = torch.zeros((n,) + src.shape[1:], dtype=src.dtype)
    return out.index_add_(0, seg, src)
def _pad(x, pw):
    flat = tuple(v for pair in reversed(pw) for v in pair)
    return torch.nn.functional.pad(x, flat)

kernel_name = 'gather_scatter__edge_featured_mpnn_mpnn__graph'

def setup_inputs():

    _w = (lambda a: (lambda t: t.to(torch.bfloat16) if t.is_floating_point() else t)(torch.as_tensor(a)))
    N, deg, D, De = 25000, 16, 128, max(0, 1)
    E = N * deg
    H = 2 * D
    return {
        "x": _w((lambda *s: torch.randn(*s, dtype=torch.bfloat16) * 0.05)(N, D)),
        "e_attr": _w((lambda *s: torch.randn(*s, dtype=torch.bfloat16) * 1.6)(E, De)),
        "src": _w((lambda lo, hi, *s: torch.randint(lo, hi, s))(0, N, E).to(torch.int64)),
        "dst": _w((lambda lo, hi, *s: torch.randint(lo, hi, s))(0, N, E).to(torch.int64)),
        "w1": _w((lambda *s: torch.randn(*s, dtype=torch.bfloat16) * 1.6)(2 * D + De, H) * (1.0 / (2 * D + De) ** 0.5)),
        "b1": _w((lambda *s: torch.randn(*s, dtype=torch.bfloat16) * 1.6)(H) * 0.01),
        "w2": _w((lambda *s: torch.randn(*s, dtype=torch.bfloat16) * 0.05)(H, D) * (1.0 / H ** 0.5)),
        "b2": _w((lambda *s: torch.randn(*s, dtype=torch.bfloat16) * 0.05)(D) * 0.01),
    }

def reference(x, e_attr, src, dst, w1, b1, w2, b2):
    N, D = x.shape
    h_src = x[src]
    h_dst = x[dst]
    m_in = torch.concatenate([h_src, h_dst, e_attr], axis=-1)
    h = _silu(m_in @ w1 + b1)
    msg = h @ w2 + b2
    return _segment_sum(msg, dst, N)
```

```asm
; @launch kernel=gather_scatter__edge_featured_mpnn_mpnn__graph_kernel grid=(256,1,1) block=(1024,1,1) lds=160064
.amdgcn_target "amdgcn-amd-amdhsa--gfx950"
.text
.globl gather_scatter__edge_featured_mpnn_mpnn__graph_kernel
.p2align 8
.type gather_scatter__edge_featured_mpnn_mpnn__graph_kernel,@function
gather_scatter__edge_featured_mpnn_mpnn__graph_kernel:
    s_cmp_ge_u32 s2, 256
    s_cbranch_scc1 K2_END
    s_load_dwordx16 s[4:19], s[0:1], 0
    s_load_dwordx2 s[20:21], s[0:1], 64
    s_load_dwordx2 s[22:23], s[0:1], 80
    s_load_dwordx2 s[100:101], s[0:1], 72
    v_lshrrev_b32 v1, 6, v0
    v_and_b32 v2, 15, v0
    v_readfirstlane_b32 s3, v1
    v_and_b32 v1, 63, v0
    v_lshrrev_b32 v3, 4, v1
    s_mul_i32 s29, s2, 1564
    s_sub_u32 s30, 400000, s29
    s_min_u32 s30, s30, 1564
    s_lshr_b32 s30, s30, 1
    v_lshl_add_u32 v6, v0, 1, s29
    v_lshlrev_b32 v7, 1, v6
    v_lshlrev_b32 v6, 2, v6
    v_cmp_gt_u32 s[32:33], s30, v0
    v_mov_b32 v11, 0
    v_lshlrev_b32 v12, 2, v0
    v_cmp_gt_u32 vcc, 576, v0
    s_mov_b64 exec, vcc
    ds_write_b32 v12, v11 offset:0
    s_mov_b64 exec, 0xff
    v_cmp_eq_u32 vcc, 4, v1
    v_lshlrev_b32 v12, 2, v1
    s_mul_i32 s26, s2, 98
    v_cndmask_b32 v11, 0, 16, vcc
    ds_write_b32 v12, v11 offset:4416
    s_mov_b64 exec, -1
    v_lshlrev_b32 v13, 3, v1
    s_mov_b32 s68, 131072
    s_waitcnt lgkmcnt(0)
    s_mov_b32 s52, s10
    s_mov_b32 s53, s11
    s_mov_b32 s54, 1600000
    s_mov_b32 s55, 0x00020000
    s_mov_b32 s60, s6
    s_mov_b32 s61, s7
    s_mov_b32 s62, 800000
    s_mov_b32 s63, 0x00020000
    s_mov_b32 s56, s8
    s_mov_b32 s57, s9
    s_mov_b32 s58, 1600000
    s_mov_b32 s59, 0x00020000
    s_mov_b32 s40, s12
    s_mov_b32 s41, s13
    s_mov_b32 s42, 131584
    s_mov_b32 s43, 0x00020000
    s_mov_b64 exec, s[32:33]
    buffer_load_dwordx2 v[118:119], v6, s[52:55], 0 offen
    buffer_load_dword v10, v7, s[60:63], 0 offen
    buffer_load_dwordx2 v[8:9], v6, s[56:59], 0 offen
    s_mov_b64 exec, -1
    buffer_load_dwordx2 v[14:15], v13, s[40:43], s68 offen
    s_cmp_lg_u32 s3, 14
    s_cbranch_scc1 K1_NOW2L
    s_mov_b32 s64, s16
    s_mov_b32 s65, s17
    s_mov_b32 s66, 65536
    s_mov_b32 s67, 0x00020000
    s_lshr_b32 s68, s2, 2
    s_and_b32 s69, s2, 3
    s_and_b32 s24, s68, 7
    s_lshl_b32 s24, s24, 5
    s_lshl_b32 s69, s69, 2
    s_add_u32 s24, s24, s69
    s_lshl_b32 s24, s24, 8
    s_lshr_b32 s69, s68, 4
    s_lshl_b32 s69, s69, 5
    s_bfe_u32 s68, s68, 0x10003
    s_lshl_b32 s68, s68, 2
    s_add_u32 s68, s68, s69
    v_lshrrev_b32 v28, 2, v2
    v_lshlrev_b32 v28, 3, v28
    v_and_b32 v29, 3, v2
    v_add3_u32 v28, v28, v29, s68
    v_lshlrev_b32 v28, 1, v28
    s_mov_b64 exec, 0xffff
    buffer_load_ushort v20, v28, s[64:67], s24 offen offset:0
    buffer_load_ushort v24, v28, s[64:67], s24 offen offset:256
    buffer_load_ushort v21, v28, s[64:67], s24 offen offset:512
    buffer_load_ushort v25, v28, s[64:67], s24 offen offset:768
    s_add_u32 s24, s24, 4096
    buffer_load_ushort v22, v28, s[64:67], s24 offen offset:0
    buffer_load_ushort v26, v28, s[64:67], s24 offen offset:256
    buffer_load_ushort v23, v28, s[64:67], s24 offen offset:512
    buffer_load_ushort v27, v28, s[64:67], s24 offen offset:768
    s_mov_b64 exec, -1
K1_NOW2L:
    s_cmp_lg_u32 s3, 13
    s_cbranch_scc1 K1_NOWARM
    s_lshr_b32 s24, s2, 3
    s_lshl_b32 s24, s24, 11
    s_add_u32 s24, s24, 65536
    v_lshlrev_b32 v28, 5, v1
    buffer_load_dword v29, v28, s[40:43], s24 offen
K1_NOWARM:
    s_and_b32 s27, s3, 1
    s_lshl_b32 s27, s27, 7
    v_lshrrev_b32 v5, 5, v1
    v_mul_u32_u24 v5, 544, v5
    v_and_b32 v16, 31, v1
    v_lshlrev_b32 v16, 4, v16
    v_xor_b32 v16, v5, v16
    v_xor_b32 v16, s27, v16
    v_xor_b32 v17, 64, v16
    s_lshl_b32 s27, s3, 12
    s_mov_b32 s36, s4
    s_mov_b32 s37, s5
    s_mov_b32 s38, 6400000
    s_mov_b32 s39, 0x00020000
    s_mov_b32 s48, s22
    s_mov_b32 s49, s23
    s_mov_b32 s50, 33554432
    s_mov_b32 s51, 0x00020000
    s_mov_b32 s44, s14
    s_mov_b32 s45, s15
    s_mov_b32 s46, 512
    s_mov_b32 s47, 0x00020000
    s_barrier
    s_cmp_ge_u32 s3, 14
    s_cbranch_scc1 K1_NOX
    s_and_b32 s24, s3, 1
    s_lshl_b32 s24, s24, 3
    v_add_u32 v6, s24, v3
    v_xor_b32 v6, v2, v6
    s_lshl_b32 s24, s3, 3
    s_add_u32 s24, s24, s26
    v_add_u32 v5, s24, v3
    v_lshlrev_b32 v5, 8, v5
    v_lshl_add_u32 v5, v6, 4, v5
    s_lshl_b32 s24, s3, 11
    s_add_u32 m0, s24, 6656
    v_xor_b32 v6, 64, v5
    buffer_load_dwordx4 v5, s[36:39], 0 offen lds
    buffer_load_dwordx4 v6, s[36:39], 0 offen offset:1024 lds
K1_NOX:
    s_add_u32 m0, s27, 56064
    s_add_u32 s24, s27, 0
    buffer_load_dwordx4 v16, s[40:43], s24 offen offset:0 lds
    buffer_load_dwordx4 v17, s[40:43], s24 offen offset:1024 lds
    buffer_load_dwordx4 v16, s[40:43], s24 offen offset:2048 lds
    buffer_load_dwordx4 v17, s[40:43], s24 offen offset:3072 lds
    s_and_b32 s24, s3, 7
    s_lshl_b32 s24, s24, 6
    v_lshlrev_b32 v5, 3, v3
    buffer_load_dwordx2 v[112:113], v5, s[44:47], s24 offen
    buffer_load_dwordx2 v[114:115], v5, s[44:47], s24 offen offset:32
    s_mov_b32 s71, 42800
    s_mov_b32 s34, 0xbfb8aa3b
    s_lshl_b32 s31, s2, 8
    s_add_u32 s31, s31, 12845056
    s_cmp_ge_u32 s3, 13
    s_cbranch_scc1 K1_AUX
    s_waitcnt vmcnt(8)
    v_and_b32 v14, 0x7fff7fff, v14
    v_and_b32 v15, 0x7fff7fff, v15
    v_pk_max_u16 v14, v14, v15
    s_mov_b64 exec, s[32:33]
    v_mul_u32_u24 v116, s71, v118
    v_mul_u32_u24 v117, s71, v119
    v_lshrrev_b32 v116, 22, v116
    v_lshrrev_b32 v117, 22, v117
    v_mul_u32_u24 v125, 98, v116
    v_mul_u32_u24 v126, 98, v117
    v_lshlrev_b32 v116, 2, v116
    v_lshlrev_b32 v117, 2, v117
    v_sub_u32 v125, v118, v125
    v_sub_u32 v126, v119, v126
    v_mov_b32 v127, 1
    ds_add_rtn_u32 v118, v116, v127 offset:1280
    ds_add_rtn_u32 v119, v117, v127 offset:1280
    s_mov_b64 exec, -1
    v_lshlrev_b32 v15, 16, v14
    v_and_b32 v14, 0xffff0000, v14
    v_max_u32 v14, v14, v15
    s_nop 1
    v_max_u32_dpp v14, v14, v14 row_shr:1 row_mask:0xf bank_mask:0xf
    s_nop 1
    v_max_u32_dpp v14, v14, v14 row_shr:2 row_mask:0xf bank_mask:0xf
    s_nop 1
    v_max_u32_dpp v14, v14, v14 row_shr:4 row_mask:0xf bank_mask:0xf
    s_nop 1
    v_max_u32_dpp v14, v14, v14 row_shr:8 row_mask:0xf bank_mask:0xf
    s_nop 1
    v_max_u32_dpp v14, v14, v14 row_bcast:15 row_mask:0xa bank_mask:0xf
    s_nop 1
    v_max_u32_dpp v14, v14, v14 row_bcast:31 row_mask:0xc bank_mask:0xf
    v_mul_f32 v14, 0x40b8aa3b, v14
    v_lshlrev_b32 v121, 16, v10
    v_readlane_b32 s67, v14, 63
    v_and_b32 v123, 0xffff0000, v10
    s_mov_b64 exec, s[32:33]
    v_fma_f32 v120, |v121|, s67, 1.0
    v_fma_f32 v122, |v123|, s67, 1.0
    v_lshl_or_b32 v121, v125, 2, v121
    v_lshl_or_b32 v123, v126, 2, v123
    v_cvt_u32_f32 v120, v120
    v_cvt_u32_f32 v122, v122
    v_min_u32 v120, 585, v120
    v_min_u32 v122, 585, v122
    v_lshl_or_b32 v120, v120, 16, v8
    v_lshl_or_b32 v122, v122, 16, v9
    v_lshlrev_b32 v125, 5, v116
    v_lshlrev_b32 v126, 5, v117
    v_add_u32 v125, 121600, v125
    v_add_u32 v126, 121600, v126
    s_waitcnt lgkmcnt(0)
    v_lshl_add_u32 v125, v118, 3, v125
    v_lshl_add_u32 v126, v119, 3, v126
    v_cmp_gt_u32 s[72:73], 16, v118
    v_cmp_gt_u32 s[74:75], 16, v119
    v_max_u32 v124, v118, v119
    s_mov_b64 exec, s[72:73]
    ds_write_b64 v125, v[120:121]
    s_mov_b64 exec, s[74:75]
    ds_write_b64 v126, v[122:123]
    s_and_b64 s[76:77], s[72:73], s[74:75]
    s_andn2_b64 exec, s[32:33], s[76:77]
    s_cbranch_execz K1_BAR1
    v_lshlrev_b32 v125, 14, v116
    v_lshlrev_b32 v126, 14, v117
    v_lshl_add_u32 v125, v118, 3, v125
    v_lshl_add_u32 v126, v119, 3, v126
    v_cmp_gt_u32 s[76:77], 24, v118
    v_cmp_gt_u32 s[78:79], 24, v119
    v_cmp_le_u32 vcc, 24, v124
    v_mov_b32 v127, 0
    s_andn2_b64 exec, s[76:77], s[72:73]
    buffer_store_dwordx2 v[120:121], v125, s[48:51], s31 offen sc1
    s_andn2_b64 exec, s[78:79], s[74:75]
    buffer_store_dwordx2 v[122:123], v126, s[48:51], s31 offen sc1
    s_mov_b64 exec, vcc
    ds_max_u32 v127, v124 offset:4440
    s_branch K1_BAR1
K1_AUX:
    s_cmp_lg_u32 s3, 15
    s_cbranch_scc1 K1_BAR1
    s_and_b32 s64, s2, 31
    s_lshl_b32 s64, s64, 7
    s_add_u32 s64, s64, 33226752
    v_mov_b32 v30, 0
    buffer_load_dwordx4 v[26:29], v30, s[48:51], s64 offen sc1
    s_waitcnt vmcnt(7)
    v_lshlrev_b32 v20, 16, v14
    v_and_b32 v21, 0xffff0000, v14
    v_lshlrev_b32 v22, 16, v15
    v_and_b32 v23, 0xffff0000, v15
    v_mul_f32 v20, s34, v20
    v_mul_f32 v21, s34, v21
    v_mul_f32 v22, s34, v22
    v_mul_f32 v23, s34, v23
    v_and_b32 v24, 3, v1
    v_lshlrev_b32 v24, 4, v24
    v_bfe_u32 v25, v1, 3, 2
    v_lshl_add_u32 v24, v25, 6, v24
    v_bfe_u32 v25, v1, 2, 1
    v_lshl_add_u32 v24, v25, 8, v24
    v_lshrrev_b32 v25, 5, v1
    v_lshl_add_u32 v24, v25, 9, v24
    ds_write_b128 v24, v[20:23] offset:4480
K1_BAR1:
    s_mov_b64 exec, -1
    v_lshrrev_b32 v6, 2, v0
    v_and_b32 v7, 3, v0
    v_lshlrev_b32 v127, 1, v7
    v_lshlrev_b32 v7, 4, v7
    v_lshl_add_u32 v5, v6, 7, v7
    v_add_u32 v5, 121600, v5
    v_lshl_add_u32 v126, v6, 8, v7
    v_lshl_add_u32 v7, v6, 16, v7
    v_and_b32 v6, 0x3fc, v0
    v_mov_b32 v4, 0
    s_waitcnt lgkmcnt(0)
    s_barrier
    ds_read_b32 v108, v6 offset:1280
    ds_read_b128 v[100:103], v5
    ds_read_b128 v[104:107], v5 offset:64
    ds_read_b32 v109, v4 offset:4440
    s_mov_b32 s24, 0x11111111
    s_mov_b32 s25, 0x11111111
    s_movk_i32 s28, 0x3e00
    s_waitcnt lgkmcnt(3)
    v_sub_u32 v110, v108, v127
    v_min_u32 v108, 31, v108
    v_lshlrev_b32 v108, 9, v108
    v_cmp_lt_i32 vcc, 0, v110
    v_cmp_lt_i32 s[72:73], 8, v110
    s_waitcnt lgkmcnt(0)
    v_readfirstlane_b32 s29, v109
    s_mov_b64 exec, s[24:25]
    v_bfi_b32 v101, s28, v108, v101
    s_or_b64 exec, vcc, s[24:25]
    buffer_store_dwordx4 v[100:103], v7, s[48:51], s31 offen sc1
    s_mov_b64 exec, s[72:73]
    buffer_store_dwordx4 v[104:107], v7, s[48:51], s31 offen offset:64 sc1
    s_mov_b64 exec, -1
    s_cmp_eq_u32 s29, 0
    s_cbranch_scc1 K1_NOPACK
    s_cmp_lg_u32 s3, 15
    s_cbranch_scc1 K1_NOSCAN
    v_lshlrev_b32 v6, 4, v1
    ds_read_b128 v[52:55], v6 offset:1280
    s_lshl_b32 s24, s2, 10
    s_add_u32 s24, s24, 32833536
    s_waitcnt lgkmcnt(0)
    v_add_u32 v57, v52, v53
    v_add_u32 v58, v57, v54
    v_add_u32 v59, v58, v55
    v_mov_b32 v60, v59
    s_nop 1
    v_add_u32_dpp v60, v60, v60 row_shr:1 row_mask:0xf bank_mask:0xf
    s_nop 1
    v_add_u32_dpp v60, v60, v60 row_shr:2 row_mask:0xf bank_mask:0xf
    s_nop 1
    v_add_u32_dpp v60, v60, v60 row_shr:4 row_mask:0xf bank_mask:0xf
    s_nop 1
    v_add_u32_dpp v60, v60, v60 row_shr:8 row_mask:0xf bank_mask:0xf
    s_nop 1
    v_add_u32_dpp v60, v60, v60 row_bcast:15 row_mask:0xa bank_mask:0xf
    s_nop 1
    v_add_u32_dpp v60, v60, v60 row_bcast:31 row_mask:0xc bank_mask:0xf
    v_sub_u32 v60, v60, v59
    v_add_u32 v61, v60, v52
    v_add_u32 v62, v60, v57
    v_add_u32 v63, v60, v58
    v_lshlrev_b32 v64, 3, v60
    v_lshlrev_b32 v65, 3, v61
    v_lshlrev_b32 v66, 3, v62
    v_lshlrev_b32 v67, 3, v63
    ds_write_b128 v6, v[64:67] offset:5504
    v_lshl_or_b32 v60, v52, 16, v60
    v_lshl_or_b32 v61, v53, 16, v61
    v_lshl_or_b32 v62, v54, 16, v62
    v_lshl_or_b32 v63, v55, 16, v63
    buffer_store_dwordx4 v[60:63], v6, s[48:51], s24 offen sc1
    s_waitcnt lgkmcnt(0)
K1_NOSCAN:
    s_barrier
    s_mov_b64 exec, s[32:33]
    ds_read_b32 v116, v116 offset:5504
    ds_read_b32 v117, v117 offset:5504
    s_waitcnt lgkmcnt(0)
    v_lshl_add_u32 v116, v118, 3, v116
    v_lshl_add_u32 v117, v119, 3, v117
    ds_write_b64 v116, v[120:121] offset:39424
    ds_write_b64 v117, v[122:123] offset:39424
    s_mov_b64 exec, -1
    v_lshlrev_b32 v6, 4, v0
    v_cmp_gt_u32 vcc, 784, v0
    s_mul_i32 s24, s2, 12544
    s_add_u32 s24, s24, 29622272
    s_waitcnt lgkmcnt(0)
    s_barrier
    s_mov_b64 exec, vcc
    ds_read_b128 v[52:55], v6 offset:39424
    s_waitcnt lgkmcnt(0)
    buffer_store_dwordx4 v[52:55], v6, s[48:51], s24 offen sc1
    s_mov_b64 exec, -1
    s_waitcnt vmcnt(0)
K1_NOPACK:
K1_ADDR:
    v_lshrrev_b32 v11, 2, v2
    v_mul_u32_u24 v4, 544, v11
    v_lshl_add_u32 v4, v3, 12, v4
    v_and_b32 v11, 1, v3
    v_lshl_add_u32 v4, v11, 7, v4
    v_and_b32 v11, 3, v2
    v_lshl_add_u32 v4, v11, 3, v4
    s_and_b32 s24, s3, 7
    s_lshl_b32 s24, s24, 6
    v_xor_b32 v4, s24, v4
    v_add_u32 v4, 56064, v4
    v_xor_b32 v5, 32, v4
    v_xor_b32 v11, v2, v3
    v_lshlrev_b32 v11, 4, v11
    v_lshl_add_u32 v6, v2, 8, v11
    s_lshr_b32 s24, s3, 3
    s_lshl_b32 s24, s24, 14
    s_add_u32 s24, s24, 6656
    v_add_u32 v6, s24, v6
    v_xor_b32 v7, 64, v6
    v_xor_b32 v8, 0x80, v6
    v_xor_b32 v9, 0xc0, v6
    s_mov_b32 s65, 0x07060100
    s_mov_b32 s66, 0x07060302
    s_lshr_b32 s29, s3, 3
    s_lshl_b32 s30, s29, 6
    s_sub_u32 s28, 25000, s26
    s_min_u32 s28, s28, 98
    s_sub_u32 s28, s28, s30
    s_add_u32 s30, s30, s26
    v_add_u32 v119, s30, v2
    v_lshlrev_b32 v119, 8, v119
    s_and_b32 s24, s3, 3
    s_lshl_b32 s24, s24, 6
    v_lshl_add_u32 v18, v3, 4, s24
    v_add_u32 v119, v119, v18
    s_bfe_u32 s30, s3, 0x10002
    s_mul_i32 s25, s30, 6400000
    s_mul_i32 s29, s29, 66560
    s_lshl_b32 s30, s30, 9
    s_add_u32 s29, s29, s30
    s_add_u32 s29, s29, 56064
    v_mul_u32_u24 v19, 1040, v2
    v_add3_u32 v18, v18, v19, s29
    v_mov_b32 v118, 0
    v_mov_b32 v19, 0
    s_waitcnt vmcnt(2)
    s_cmp_lg_u32 s3, 14
    s_cbranch_scc1 K1_NOW2S
    s_lshl_b32 s68, s2, 8
    s_add_u32 s68, s68, 33095680
    v_lshlrev_b32 v13, 4, v2
    s_mov_b64 exec, 0xffff
    v_lshl_or_b32 v84, v24, 16, v20
    v_lshl_or_b32 v85, v25, 16, v21
    v_lshl_or_b32 v86, v26, 16, v22
    v_lshl_or_b32 v87, v27, 16, v23
    buffer_store_dwordx4 v[84:87], v13, s[48:51], s68 offen sc1
    s_mov_b64 exec, -1
K1_NOW2S:
    s_cmp_lg_u32 s3, 15
    s_cbranch_scc1 K1_NOFL
    v_readfirstlane_b32 s60, v26
    v_readfirstlane_b32 s61, v27
    v_readfirstlane_b32 s62, v28
    v_readfirstlane_b32 s63, v29
K1_NOFL:
    v_mov_b32 v120, v16
    v_mov_b32 v121, v17
    s_barrier
    ds_read_b64_tr_b16 v[20:21], v4 offset:0
    ds_read_b64_tr_b16 v[22:23], v4 offset:2048
    ds_read_b64_tr_b16 v[36:37], v5 offset:0
    ds_read_b64_tr_b16 v[38:39], v5 offset:2048
    ds_read_b64_tr_b16 v[24:25], v4 offset:16384
    ds_read_b64_tr_b16 v[26:27], v4 offset:18432
    ds_read_b64_tr_b16 v[40:41], v5 offset:16384
    ds_read_b64_tr_b16 v[42:43], v5 offset:18432
    ds_read_b64_tr_b16 v[28:29], v4 offset:32768
    ds_read_b64_tr_b16 v[30:31], v4 offset:34816
    ds_read_b64_tr_b16 v[44:45], v5 offset:32768
    ds_read_b64_tr_b16 v[46:47], v5 offset:34816
    ds_read_b64_tr_b16 v[32:33], v4 offset:49152
    ds_read_b64_tr_b16 v[34:35], v4 offset:51200
    ds_read_b64_tr_b16 v[48:49], v5 offset:49152
    ds_read_b64_tr_b16 v[50:51], v5 offset:51200
    ds_read_b128 v[52:55], v6 offset:0
    ds_read_b128 v[56:59], v7 offset:0
    ds_read_b128 v[60:63], v8 offset:0
    ds_read_b128 v[64:67], v9 offset:0
    ds_read_b128 v[68:71], v6 offset:4096
    ds_read_b128 v[72:75], v7 offset:4096
    ds_read_b128 v[76:79], v8 offset:4096
    ds_read_b128 v[80:83], v9 offset:4096
    v_lshlrev_b32 v10, 16, v112
    v_and_b32 v11, 0xffff0000, v112
    v_lshlrev_b32 v12, 16, v113
    v_and_b32 v13, 0xffff0000, v113
    v_lshlrev_b32 v14, 16, v114
    v_and_b32 v15, 0xffff0000, v114
    v_lshlrev_b32 v16, 16, v115
    v_and_b32 v17, 0xffff0000, v115
    s_waitcnt lgkmcnt(8)
    s_barrier
    s_add_u32 m0, s27, 56064
    s_add_u32 s24, s27, 65536
    buffer_load_dwordx4 v120, s[40:43], s24 offen offset:0 lds
    buffer_load_dwordx4 v121, s[40:43], s24 offen offset:1024 lds
    buffer_load_dwordx4 v120, s[40:43], s24 offen offset:2048 lds
    buffer_load_dwordx4 v121, s[40:43], s24 offen offset:3072 lds
    s_waitcnt lgkmcnt(4)
    v_mfma_f32_16x16x32_bf16 v[84:87], v[20:23], v[52:55], 0
    v_mfma_f32_16x16x32_bf16 v[88:91], v[36:39], v[52:55], 0
    v_mfma_f32_16x16x32_bf16 v[84:87], v[24:27], v[56:59], v[84:87]
    v_mfma_f32_16x16x32_bf16 v[88:91], v[40:43], v[56:59], v[88:91]
    v_mfma_f32_16x16x32_bf16 v[84:87], v[28:31], v[60:63], v[84:87]
    v_mfma_f32_16x16x32_bf16 v[88:91], v[44:47], v[60:63], v[88:91]
    v_mfma_f32_16x16x32_bf16 v[84:87], v[32:35], v[64:67], v[84:87]
    v_mfma_f32_16x16x32_bf16 v[88:91], v[48:51], v[64:67], v[88:91]
    ds_read_b128 v[52:55], v6 offset:8192
    ds_read_b128 v[56:59], v7 offset:8192
    ds_read_b128 v[60:63], v8 offset:8192
    ds_read_b128 v[64:67], v9 offset:8192
    s_waitcnt vmcnt(4)
    s_barrier
    s_cmp_lg_u32 s3, 15
    s_cbranch_scc1 K1_SIGA
    s_and_b32 s24, s2, 1
    s_lshl_b32 s24, s24, 7
    v_mov_b32 v124, s24
    v_mov_b32 v125, 1
    s_mov_b64 exec, 1
    global_atomic_add v125, v124, v125, s[100:101] sc0 sc1
    s_mov_b64 exec, -1
K1_SIGA:
    s_waitcnt lgkmcnt(4)
    v_mfma_f32_16x16x32_bf16 v[92:95], v[20:23], v[68:71], 0
    v_mfma_f32_16x16x32_bf16 v[96:99], v[36:39], v[68:71], 0
    v_mfma_f32_16x16x32_bf16 v[92:95], v[24:27], v[72:75], v[92:95]
    v_mfma_f32_16x16x32_bf16 v[96:99], v[40:43], v[72:75], v[96:99]
    v_mfma_f32_16x16x32_bf16 v[92:95], v[28:31], v[76:79], v[92:95]
    v_mfma_f32_16x16x32_bf16 v[96:99], v[44:47], v[76:79], v[96:99]
    v_mfma_f32_16x16x32_bf16 v[92:95], v[32:35], v[80:83], v[92:95]
    v_mfma_f32_16x16x32_bf16 v[96:99], v[48:51], v[80:83], v[96:99]
    ds_read_b128 v[68:71], v6 offset:12288
    ds_read_b128 v[72:75], v7 offset:12288
    ds_read_b128 v[76:79], v8 offset:12288
    ds_read_b128 v[80:83], v9 offset:12288
    v_fma_f32 v84, v84, s34, 0
    v_fma_f32 v85, v85, s34, 0
    v_fma_f32 v86, v86, s34, 0
    v_fma_f32 v87, v87, s34, 0
    v_fma_f32 v88, v88, s34, 0
    v_fma_f32 v89, v89, s34, 0
    v_fma_f32 v90, v90, s34, 0
    v_fma_f32 v91, v91, s34, 0
    v_cvt_pk_bf16_f32 v116, v84, v85
    v_cvt_pk_bf16_f32 v117, v86, v87
    v_max3_f32 v118, |v84|, |v85|, v118
    v_max3_f32 v118, |v86|, |v87|, v118
    v_max3_f32 v118, |v88|, |v89|, v118
    v_max3_f32 v118, |v90|, |v91|, v118
    v_add_u32 v88, 0x8000, v88
    v_add_u32 v89, 0x8000, v89
    v_add_u32 v90, 0x8000, v90
    v_add_u32 v91, 0x8000, v91
    v_sub_u32_sdwa v88, v88, v116 clamp dst_sel:DWORD dst_unused:UNUSED_PAD src0_sel:DWORD src1_sel:WORD_0
    v_sub_u32_sdwa v89, v89, v116 clamp dst_sel:DWORD dst_unused:UNUSED_PAD src0_sel:DWORD src1_sel:WORD_1
    v_sub_u32_sdwa v90, v90, v117 clamp dst_sel:DWORD dst_unused:UNUSED_PAD src0_sel:DWORD src1_sel:WORD_0
    v_sub_u32_sdwa v91, v91, v117 clamp dst_sel:DWORD dst_unused:UNUSED_PAD src0_sel:DWORD src1_sel:WORD_1
    v_perm_b32 v84, v88, v116, s65
    v_perm_b32 v85, v89, v116, s66
    v_perm_b32 v86, v90, v117, s65
    v_perm_b32 v87, v91, v117, s66
    v_cmp_gt_i32 vcc, s28, v2
    s_mov_b64 exec, vcc
    buffer_store_dwordx4 v[84:87], v119, s[48:51], s25 offen sc1
    s_mov_b64 exec, -1
    s_sub_u32 s28, s28, 16
    s_add_u32 s25, s25, 4096
    s_cmp_lg_u32 s3, 15
    s_cbranch_scc1 K1_RELA
    s_waitcnt vmcnt(1)
    v_readfirstlane_b32 s24, v125
    s_bfe_u32 s24, s24, 0x100000
    s_cmp_lg_u32 s24, 127
    s_cbranch_scc1 K1_RELA
    s_and_b32 s24, s2, 1
    s_lshl_b32 s24, s24, 2
    s_add_u32 s24, s24, 33226752
    v_lshlrev_b32 v124, 7, v1
    v_mov_b32 v125, 1
    s_mov_b32 exec_hi, 0
    buffer_atomic_add v125, v124, s[48:51], s24 offen sc1
    s_mov_b64 exec, -1
    s_waitcnt vmcnt(0)
K1_RELA:
    s_waitcnt lgkmcnt(4)
    v_mfma_f32_16x16x32_bf16 v[84:87], v[20:23], v[52:55], 0
    v_mfma_f32_16x16x32_bf16 v[88:91], v[36:39], v[52:55], 0
    v_mfma_f32_16x16x32_bf16 v[84:87], v[24:27], v[56:59], v[84:87]
    v_mfma_f32_16x16x32_bf16 v[88:91], v[40:43], v[56:59], v[88:91]
    v_mfma_f32_16x16x32_bf16 v[84:87], v[28:31], v[60:63], v[84:87]
    v_mfma_f32_16x16x32_bf16 v[88:91], v[44:47], v[60:63], v[88:91]
    v_mfma_f32_16x16x32_bf16 v[84:87], v[32:35], v[64:67], v[84:87]
    v_mfma_f32_16x16x32_bf16 v[88:91], v[48:51], v[64:67], v[88:91]
    v_fma_f32 v92, v92, s34, 0
    v_fma_f32 v93, v93, s34, 0
    v_fma_f32 v94, v94, s34, 0
    v_fma_f32 v95, v95, s34, 0
    v_fma_f32 v96, v96, s34, 0
    v_fma_f32 v97, v97, s34, 0
    v_fma_f32 v98, v98, s34, 0
    v_fma_f32 v99, v99, s34, 0
    v_cvt_pk_bf16_f32 v116, v92, v93
    v_cvt_pk_bf16_f32 v117, v94, v95
    v_max3_f32 v118, |v92|, |v93|, v118
    v_max3_f32 v118, |v94|, |v95|, v118
    v_max3_f32 v118, |v96|, |v97|, v118
    v_max3_f32 v118, |v98|, |v99|, v118
    v_add_u32 v96, 0x8000, v96
    v_add_u32 v97, 0x8000, v97
    v_add_u32 v98, 0x8000, v98
    v_add_u32 v99, 0x8000, v99
    v_sub_u32_sdwa v96, v96, v116 clamp dst_sel:DWORD dst_unused:UNUSED_PAD src0_sel:DWORD src1_sel:WORD_0
    v_sub_u32_sdwa v97, v97, v116 clamp dst_sel:DWORD dst_unused:UNUSED_PAD src0_sel:DWORD src1_sel:WORD_1
    v_sub_u32_sdwa v98, v98, v117 clamp dst_sel:DWORD dst_unused:UNUSED_PAD src0_sel:DWORD src1_sel:WORD_0
    v_sub_u32_sdwa v99, v99, v117 clamp dst_sel:DWORD dst_unused:UNUSED_PAD src0_sel:DWORD src1_sel:WORD_1
    v_perm_b32 v92, v96, v116, s65
    v_perm_b32 v93, v97, v116, s66
    v_perm_b32 v94, v98, v117, s65
    v_perm_b32 v95, v99, v117, s66
    v_cmp_gt_i32 vcc, s28, v2
    s_mov_b64 exec, vcc
    buffer_store_dwordx4 v[92:95], v119, s[48:51], s25 offen sc1
    s_mov_b64 exec, -1
    s_sub_u32 s28, s28, 16
    s_add_u32 s25, s25, 4096
    s_cmp_ge_u32 s3, 8
    s_cbranch_scc1 K1_RH1
    s_waitcnt lgkmcnt(0)
    v_mfma_f32_16x16x32_bf16 v[92:95], v[20:23], v[68:71], 0
    v_mfma_f32_16x16x32_bf16 v[96:99], v[36:39], v[68:71], 0
    v_mfma_f32_16x16x32_bf16 v[92:95], v[24:27], v[72:75], v[92:95]
    v_mfma_f32_16x16x32_bf16 v[96:99], v[40:43], v[72:75], v[96:99]
    v_mfma_f32_16x16x32_bf16 v[92:95], v[28:31], v[76:79], v[92:95]
    v_mfma_f32_16x16x32_bf16 v[96:99], v[44:47], v[76:79], v[96:99]
    v_mfma_f32_16x16x32_bf16 v[92:95], v[32:35], v[80:83], v[92:95]
    v_mfma_f32_16x16x32_bf16 v[96:99], v[48:51], v[80:83], v[96:99]
    v_fma_f32 v84, v84, s34, 0
    v_fma_f32 v85, v85, s34, 0
    v_fma_f32 v86, v86, s34, 0
    v_fma_f32 v87, v87, s34, 0
    v_fma_f32 v88, v88, s34, 0
    v_fma_f32 v89, v89, s34, 0
    v_fma_f32 v90, v90, s34, 0
    v_fma_f32 v91, v91, s34, 0
    v_cvt_pk_bf16_f32 v116, v84, v85
    v_cvt_pk_bf16_f32 v117, v86, v87
    v_max3_f32 v118, |v84|, |v85|, v118
    v_max3_f32 v118, |v86|, |v87|, v118
    v_max3_f32 v118, |v88|, |v89|, v118
    v_max3_f32 v118, |v90|, |v91|, v118
    v_add_u32 v88, 0x8000, v88
    v_add_u32 v89, 0x8000, v89
    v_add_u32 v90, 0x8000, v90
    v_add_u32 v91, 0x8000, v91
    v_sub_u32_sdwa v88, v88, v116 clamp dst_sel:DWORD dst_unused:UNUSED_PAD src0_sel:DWORD src1_sel:WORD_0
    v_sub_u32_sdwa v89, v89, v116 clamp dst_sel:DWORD dst_unused:UNUSED_PAD src0_sel:DWORD src1_sel:WORD_1
    v_sub_u32_sdwa v90, v90, v117 clamp dst_sel:DWORD dst_unused:UNUSED_PAD src0_sel:DWORD src1_sel:WORD_0
    v_sub_u32_sdwa v91, v91, v117 clamp dst_sel:DWORD dst_unused:UNUSED_PAD src0_sel:DWORD src1_sel:WORD_1
    v_perm_b32 v84, v88, v116, s65
    v_perm_b32 v85, v89, v116, s66
    v_perm_b32 v86, v90, v117, s65
    v_perm_b32 v87, v91, v117, s66
    v_cmp_gt_i32 vcc, s28, v2
    s_mov_b64 exec, vcc
    buffer_store_dwordx4 v[84:87], v119, s[48:51], s25 offen sc1
    s_mov_b64 exec, -1
    s_sub_u32 s28, s28, 16
    s_add_u32 s25, s25, 4096
    v_fma_f32 v92, v92, s34, 0
    v_fma_f32 v93, v93, s34, 0
    v_fma_f32 v94, v94, s34, 0
    v_fma_f32 v95, v95, s34, 0
    v_fma_f32 v96, v96, s34, 0
    v_fma_f32 v97, v97, s34, 0
    v_fma_f32 v98, v98, s34, 0
    v_fma_f32 v99, v99, s34, 0
    v_cvt_pk_bf16_f32 v116, v92, v93
    v_cvt_pk_bf16_f32 v117, v94, v95
    v_max3_f32 v118, |v92|, |v93|, v118
    v_max3_f32 v118, |v94|, |v95|, v118
    v_max3_f32 v118, |v96|, |v97|, v118
    v_max3_f32 v118, |v98|, |v99|, v118
    v_add_u32 v96, 0x8000, v96
    v_add_u32 v97, 0x8000, v97
    v_add_u32 v98, 0x8000, v98
    v_add_u32 v99, 0x8000, v99
    v_sub_u32_sdwa v96, v96, v116 clamp dst_sel:DWORD dst_unused:UNUSED_PAD src0_sel:DWORD src1_sel:WORD_0
    v_sub_u32_sdwa v97, v97, v116 clamp dst_sel:DWORD dst_unused:UNUSED_PAD src0_sel:DWORD src1_sel:WORD_1
    v_sub_u32_sdwa v98, v98, v117 clamp dst_sel:DWORD dst_unused:UNUSED_PAD src0_sel:DWORD src1_sel:WORD_0
    v_sub_u32_sdwa v99, v99, v117 clamp dst_sel:DWORD dst_unused:UNUSED_PAD src0_sel:DWORD src1_sel:WORD_1
    v_perm_b32 v92, v96, v116, s65
    v_perm_b32 v93, v97, v116, s66
    v_perm_b32 v94, v98, v117, s65
    v_perm_b32 v95, v99, v117, s66
    v_cmp_gt_i32 vcc, s28, v2
    s_mov_b64 exec, vcc
    buffer_store_dwordx4 v[92:95], v119, s[48:51], s25 offen sc1
    s_mov_b64 exec, -1
    s_sub_u32 s28, s28, 16
    s_add_u32 s25, s25, 4096
    s_waitcnt vmcnt(4)
    s_branch K1_GD
K1_RH1:
    v_fma_f32 v84, v84, s34, 0
    v_fma_f32 v85, v85, s34, 0
    v_fma_f32 v86, v86, s34, 0
    v_fma_f32 v87, v87, s34, 0
    v_fma_f32 v88, v88, s34, 0
    v_fma_f32 v89, v89, s34, 0
    v_fma_f32 v90, v90, s34, 0
    v_fma_f32 v91, v91, s34, 0
    v_cvt_pk_bf16_f32 v116, v84, v85
    v_cvt_pk_bf16_f32 v117, v86, v87
    v_max3_f32 v118, |v84|, |v85|, v118
    v_max3_f32 v118, |v86|, |v87|, v118
    v_max3_f32 v118, |v88|, |v89|, v118
    v_max3_f32 v118, |v90|, |v91|, v118
    v_add_u32 v88, 0x8000, v88
    v_add_u32 v89, 0x8000, v89
    v_add_u32 v90, 0x8000, v90
    v_add_u32 v91, 0x8000, v91
    v_sub_u32_sdwa v88, v88, v116 clamp dst_sel:DWORD dst_unused:UNUSED_PAD src0_sel:DWORD src1_sel:WORD_0
    v_sub_u32_sdwa v89, v89, v116 clamp dst_sel:DWORD dst_unused:UNUSED_PAD src0_sel:DWORD src1_sel:WORD_1
    v_sub_u32_sdwa v90, v90, v117 clamp dst_sel:DWORD dst_unused:UNUSED_PAD src0_sel:DWORD src1_sel:WORD_0
    v_sub_u32_sdwa v91, v91, v117 clamp dst_sel:DWORD dst_unused:UNUSED_PAD src0_sel:DWORD src1_sel:WORD_1
    v_perm_b32 v84, v88, v116, s65
    v_perm_b32 v85, v89, v116, s66
    v_perm_b32 v86, v90, v117, s65
    v_perm_b32 v87, v91, v117, s66
    v_cmp_gt_i32 vcc, s28, v2
    s_mov_b64 exec, vcc
    buffer_store_dwordx4 v[84:87], v119, s[48:51], s25 offen sc1
    s_mov_b64 exec, -1
    s_sub_u32 s28, s28, 16
    s_add_u32 s25, s25, 4096
    s_waitcnt vmcnt(3)
K1_GD:
    s_nop 1
    v_max_f32_dpp v118, v118, v118 row_shr:1 row_mask:0xf bank_mask:0xf
    s_nop 1
    v_max_f32_dpp v118, v118, v118 row_shr:2 row_mask:0xf bank_mask:0xf
    s_nop 1
    v_max_f32_dpp v118, v118, v118 row_shr:4 row_mask:0xf bank_mask:0xf
    s_nop 1
    v_max_f32_dpp v118, v118, v118 row_shr:8 row_mask:0xf bank_mask:0xf
    v_mov_b32 v116, 0
    s_mov_b32 exec_lo, 0x80008000
    s_mov_b32 exec_hi, 0x80008000
    ds_max_u32 v116, v118 offset:4416
    s_mov_b64 exec, -1
    s_waitcnt lgkmcnt(0)
    s_barrier
    s_cmp_lg_u32 s3, 1
    s_cbranch_scc1 K1_NOPM
    ds_read_b32 v118, v116 offset:4416
    s_lshl_b32 s24, s2, 2
    s_add_u32 s24, s24, 33161216
    s_mov_b64 exec, 1
    s_waitcnt lgkmcnt(0)
    buffer_store_dword v118, v116, s[48:51], s24 offen sc1
    s_mov_b64 exec, -1
K1_NOPM:
    ds_read_b64_tr_b16 v[20:21], v4 offset:0
    ds_read_b64_tr_b16 v[22:23], v4 offset:2048
    ds_read_b64_tr_b16 v[36:37], v5 offset:0
    ds_read_b64_tr_b16 v[38:39], v5 offset:2048
    ds_read_b64_tr_b16 v[24:25], v4 offset:16384
    ds_read_b64_tr_b16 v[26:27], v4 offset:18432
    ds_read_b64_tr_b16 v[40:41], v5 offset:16384
    ds_read_b64_tr_b16 v[42:43], v5 offset:18432
    ds_read_b64_tr_b16 v[28:29], v4 offset:32768
    ds_read_b64_tr_b16 v[30:31], v4 offset:34816
    ds_read_b64_tr_b16 v[44:45], v5 offset:32768
    ds_read_b64_tr_b16 v[46:47], v5 offset:34816
    ds_read_b64_tr_b16 v[32:33], v4 offset:49152
    ds_read_b64_tr_b16 v[34:35], v4 offset:51200
    ds_read_b64_tr_b16 v[48:49], v5 offset:49152
    ds_read_b64_tr_b16 v[50:51], v5 offset:51200
    ds_read_b128 v[52:55], v6 offset:0
    ds_read_b128 v[56:59], v7 offset:0
    ds_read_b128 v[60:63], v8 offset:0
    ds_read_b128 v[64:67], v9 offset:0
    ds_read_b128 v[68:71], v6 offset:4096
    ds_read_b128 v[72:75], v7 offset:4096
    ds_read_b128 v[76:79], v8 offset:4096
    ds_read_b128 v[80:83], v9 offset:4096
    s_cmp_lg_u32 s3, 15
    s_cbranch_scc1 K2_PA_OK
    v_mov_b32 v110, 0
    s_mov_b64 exec, 1
    s_mov_b32 s24, 40000
K2_PA_SPIN:
    buffer_load_dwordx2 v[108:109], v110, s[48:51], s64 offen offset:0 sc1
    s_sub_u32 s24, s24, 1
    s_waitcnt vmcnt(0)
    v_cmp_eq_u32 vcc, s60, v108
    v_cmp_eq_u32 s[28:29], s61, v109
    s_or_b64 vcc, vcc, s[28:29]
    s_cbranch_vccz K2_PA_DONE
    s_sleep 1
    s_cmp_lg_u32 s24, 0
    s_cbranch_scc1 K2_PA_SPIN
    v_mov_b32 v108, 1
    ds_write_b32 v110, v108 offset:4436
    s_waitcnt lgkmcnt(0)
K2_PA_DONE:
    s_mov_b64 exec, -1
K2_PA_OK:
    s_lshl_b32 s24, s2, 16
    s_add_u32 s70, s24, 12845056
    s_waitcnt vmcnt(0) lgkmcnt(8)
    s_barrier
    s_cmp_lg_u32 s3, 15
    s_cbranch_scc1 K1_SIGB
    s_and_b32 s24, s2, 1
    s_lshl_b32 s24, s24, 7
    v_mov_b32 v124, s24
    v_mov_b32 v125, 65536
    s_mov_b64 exec, 1
    global_atomic_add v125, v124, v125, s[100:101] sc0 sc1
    s_mov_b64 exec, -1
K1_SIGB:
    buffer_load_dwordx4 v[100:103], v126, s[48:51], s70 offen sc1
    buffer_load_dwordx4 v[104:107], v126, s[48:51], s70 offen offset:64 sc1
    s_waitcnt lgkmcnt(4)
    v_mfma_f32_16x16x32_bf16 v[84:87], v[20:23], v[52:55], v[10:13]
    v_mfma_f32_16x16x32_bf16 v[88:91], v[36:39], v[52:55], v[14:17]
    v_mfma_f32_16x16x32_bf16 v[84:87], v[24:27], v[56:59], v[84:87]
    v_mfma_f32_16x16x32_bf16 v[88:91], v[40:43], v[56:59], v[88:91]
    v_mfma_f32_16x16x32_bf16 v[84:87], v[28:31], v[60:63], v[84:87]
    v_mfma_f32_16x16x32_bf16 v[88:91], v[44:47], v[60:63], v[88:91]
    v_mfma_f32_16x16x32_bf16 v[84:87], v[32:35], v[64:67], v[84:87]
    v_mfma_f32_16x16x32_bf16 v[88:91], v[48:51], v[64:67], v[88:91]
    ds_read_b128 v[52:55], v6 offset:8192
    ds_read_b128 v[56:59], v7 offset:8192
    ds_read_b128 v[60:63], v8 offset:8192
    ds_read_b128 v[64:67], v9 offset:8192
    s_waitcnt lgkmcnt(4)
    v_mfma_f32_16x16x32_bf16 v[92:95], v[20:23], v[68:71], v[10:13]
    v_mfma_f32_16x16x32_bf16 v[96:99], v[36:39], v[68:71], v[14:17]
    v_mfma_f32_16x16x32_bf16 v[92:95], v[24:27], v[72:75], v[92:95]
    v_mfma_f32_16x16x32_bf16 v[96:99], v[40:43], v[72:75], v[96:99]
    v_mfma_f32_16x16x32_bf16 v[92:95], v[28:31], v[76:79], v[92:95]
    v_mfma_f32_16x16x32_bf16 v[96:99], v[44:47], v[76:79], v[96:99]
    v_mfma_f32_16x16x32_bf16 v[92:95], v[32:35], v[80:83], v[92:95]
    v_mfma_f32_16x16x32_bf16 v[96:99], v[48:51], v[80:83], v[96:99]
    s_cmp_ge_u32 s3, 8
    s_cbranch_scc1 K2_NOX3
    ds_read_b128 v[68:71], v6 offset:12288
    ds_read_b128 v[72:75], v7 offset:12288
    ds_read_b128 v[76:79], v8 offset:12288
    ds_read_b128 v[80:83], v9 offset:12288
K2_NOX3:
    s_cmp_lg_u32 s3, 15
    s_cbranch_scc1 K1_RELB
    s_waitcnt vmcnt(2)
    v_readfirstlane_b32 s24, v125
    s_bfe_u32 s24, s24, 0x100010
    s_cmp_lg_u32 s24, 127
    s_cbranch_scc1 K1_RELB
    s_and_b32 s24, s2, 1
    s_lshl_b32 s24, s24, 2
    s_add_u32 s24, s24, 33226760
    v_lshlrev_b32 v124, 7, v1
    v_mov_b32 v125, 1
    s_mov_b32 exec_hi, 0
    buffer_atomic_add v125, v124, s[48:51], s24 offen sc1
    s_mov_b64 exec, -1
    s_waitcnt vmcnt(0)
K1_RELB:
    v_mul_f32 v84, s34, v84
    v_mul_f32 v85, s34, v85
    v_mul_f32 v86, s34, v86
    v_mul_f32 v87, s34, v87
    v_mul_f32 v88, s34, v88
    v_mul_f32 v89, s34, v89
    v_mul_f32 v90, s34, v90
    v_mul_f32 v91, s34, v91
    v_max3_f32 v19, |v84|, |v85|, v19
    v_max3_f32 v19, |v86|, |v87|, v19
    v_max3_f32 v19, |v88|, |v89|, v19
    v_max3_f32 v19, |v90|, |v91|, v19
    ds_write_b128 v18, v[84:87] offset:0
    ds_write_b128 v18, v[88:91] offset:256
    s_waitcnt lgkmcnt(2)
    v_mfma_f32_16x16x32_bf16 v[84:87], v[20:23], v[52:55], v[10:13]
    v_mfma_f32_16x16x32_bf16 v[88:91], v[36:39], v[52:55], v[14:17]
    v_mfma_f32_16x16x32_bf16 v[84:87], v[24:27], v[56:59], v[84:87]
    v_mfma_f32_16x16x32_bf16 v[88:91], v[40:43], v[56:59], v[88:91]
    v_mfma_f32_16x16x32_bf16 v[84:87], v[28:31], v[60:63], v[84:87]
    v_mfma_f32_16x16x32_bf16 v[88:91], v[44:47], v[60:63], v[88:91]
    v_mfma_f32_16x16x32_bf16 v[84:87], v[32:35], v[64:67], v[84:87]
    v_mfma_f32_16x16x32_bf16 v[88:91], v[48:51], v[64:67], v[88:91]
    v_mul_f32 v92, s34, v92
    v_mul_f32 v93, s34, v93
    v_mul_f32 v94, s34, v94
    v_mul_f32 v95, s34, v95
    v_mul_f32 v96, s34, v96
    v_mul_f32 v97, s34, v97
    v_mul_f32 v98, s34, v98
    v_mul_f32 v99, s34, v99
    v_max3_f32 v19, |v92|, |v93|, v19
    v_max3_f32 v19, |v94|, |v95|, v19
    v_max3_f32 v19, |v96|, |v97|, v19
    v_max3_f32 v19, |v98|, |v99|, v19
    ds_write_b128 v18, v[92:95] offset:16640
    ds_write_b128 v18, v[96:99] offset:16896
    s_cmp_ge_u32 s3, 8
    s_cbranch_scc1 K2_E2
    v_mfma_f32_16x16x32_bf16 v[92:95], v[20:23], v[68:71], v[10:13]
    v_mfma_f32_16x16x32_bf16 v[96:99], v[36:39], v[68:71], v[14:17]
    v_mfma_f32_16x16x32_bf16 v[92:95], v[24:27], v[72:75], v[92:95]
    v_mfma_f32_16x16x32_bf16 v[96:99], v[40:43], v[72:75], v[96:99]
    v_mfma_f32_16x16x32_bf16 v[92:95], v[28:31], v[76:79], v[92:95]
    v_mfma_f32_16x16x32_bf16 v[96:99], v[44:47], v[76:79], v[96:99]
    v_mfma_f32_16x16x32_bf16 v[92:95], v[32:35], v[80:83], v[92:95]
    v_mfma_f32_16x16x32_bf16 v[96:99], v[48:51], v[80:83], v[96:99]
    v_mul_f32 v84, s34, v84
    v_mul_f32 v85, s34, v85
    v_mul_f32 v86, s34, v86
    v_mul_f32 v87, s34, v87
    v_mul_f32 v88, s34, v88
    v_mul_f32 v89, s34, v89
    v_mul_f32 v90, s34, v90
    v_mul_f32 v91, s34, v91
    v_max3_f32 v19, |v84|, |v85|, v19
    v_max3_f32 v19, |v86|, |v87|, v19
    v_max3_f32 v19, |v88|, |v89|, v19
    v_max3_f32 v19, |v90|, |v91|, v19
    ds_write_b128 v18, v[84:87] offset:33280
    ds_write_b128 v18, v[88:91] offset:33536
    v_mul_f32 v92, s34, v92
    v_mul_f32 v93, s34, v93
    v_mul_f32 v94, s34, v94
    v_mul_f32 v95, s34, v95
    v_mul_f32 v96, s34, v96
    v_mul_f32 v97, s34, v97
    v_mul_f32 v98, s34, v98
    v_mul_f32 v99, s34, v99
    v_max3_f32 v19, |v92|, |v93|, v19
    v_max3_f32 v19, |v94|, |v95|, v19
    v_max3_f32 v19, |v96|, |v97|, v19
    v_max3_f32 v19, |v98|, |v99|, v19
    ds_write_b128 v18, v[92:95] offset:49920
    ds_write_b128 v18, v[96:99] offset:50176
    s_branch K2_GD
K2_E2:
    v_mul_f32 v84, s34, v84
    v_mul_f32 v85, s34, v85
    v_mul_f32 v86, s34, v86
    v_mul_f32 v87, s34, v87
    v_mul_f32 v88, s34, v88
    v_mul_f32 v89, s34, v89
    v_mul_f32 v90, s34, v90
    v_mul_f32 v91, s34, v91
    v_max3_f32 v19, |v84|, |v85|, v19
    v_max3_f32 v19, |v86|, |v87|, v19
    v_max3_f32 v19, |v88|, |v89|, v19
    v_max3_f32 v19, |v90|, |v91|, v19
    s_mov_b32 exec_lo, 0x00030003
    s_mov_b32 exec_hi, 0x00030003
    ds_write_b128 v18, v[84:87] offset:33280
    ds_write_b128 v18, v[88:91] offset:33536
    s_mov_b64 exec, -1
K2_GD:
    s_nop 1
    v_max_f32_dpp v19, v19, v19 row_shr:1 row_mask:0xf bank_mask:0xf
    s_nop 1
    v_max_f32_dpp v19, v19, v19 row_shr:2 row_mask:0xf bank_mask:0xf
    s_nop 1
    v_max_f32_dpp v19, v19, v19 row_shr:4 row_mask:0xf bank_mask:0xf
    s_nop 1
    v_max_f32_dpp v19, v19, v19 row_shr:8 row_mask:0xf bank_mask:0xf
    v_mov_b32 v4, 0
    s_mov_b32 exec_lo, 0x80008000
    s_mov_b32 exec_hi, 0x80008000
    ds_max_u32 v4, v19 offset:4420
    s_mov_b64 exec, -1
    s_mov_b32 s68, 0
    s_waitcnt vmcnt(0)
    v_bfe_u32 v124, v101, 9, 5
    s_nop 1
    v_mov_b32_dpp v124, v124 quad_perm:[0,0,0,0] row_mask:0xf bank_mask:0xf
    v_sub_u32 v125, v124, v127
    v_cmp_lt_i32 s[72:73], 0, v125
    v_cmp_lt_i32 s[74:75], 1, v125
    v_cmp_lt_i32 s[76:77], 8, v125
    v_cmp_lt_i32 s[78:79], 9, v125
    v_cmp_lt_i32 s[80:81], 16, v125
    v_cmp_lt_i32 s[82:83], 17, v125
    s_mov_b64 exec, s[80:81]
    s_cbranch_execz K2_NOM2
    buffer_load_dwordx4 v[108:111], v126, s[48:51], s70 offen offset:128 sc1
    v_cmp_lt_u32 vcc, 24, v124
    s_mov_b64 exec, vcc
    ds_max_u32 v4, v124 offset:4428
    s_waitcnt vmcnt(0)
K2_NOM2:
    s_mov_b64 exec, -1
    s_mov_b32 s35, 0xffff0000
    s_mov_b64 exec, s[72:73]
    v_and_b32 v118, 0x1fc, v101
    v_and_or_b32 v8, v100, s35, 1
    ds_add_rtn_u32 v112, v118, v8 offset:0
    v_and_b32 v100, 0xffff, v100
    v_and_b32 v101, s35, v101
    s_mov_b64 exec, s[74:75]
    v_and_b32 v119, 0x1fc, v103
    v_and_or_b32 v8, v102, s35, 1
    ds_add_rtn_u32 v113, v119, v8 offset:0
    v_and_b32 v102, 0xffff, v102
    v_and_b32 v103, s35, v103
    s_mov_b64 exec, s[76:77]
    s_cbranch_execz K2A_HISTDONE
    v_and_b32 v120, 0x1fc, v105
    v_and_or_b32 v8, v104, s35, 1
    ds_add_rtn_u32 v114, v120, v8 offset:0
    v_and_b32 v104, 0xffff, v104
    v_and_b32 v105, s35, v105
    s_mov_b64 exec, s[78:79]
    v_and_b32 v121, 0x1fc, v107
    v_and_or_b32 v8, v106, s35, 1
    ds_add_rtn_u32 v115, v121, v8 offset:0
    v_and_b32 v106, 0xffff, v106
    v_and_b32 v107, s35, v107
    s_mov_b64 exec, s[80:81]
    s_cbranch_execz K2A_HISTDONE
    v_and_b32 v122, 0x1fc, v109
    v_and_or_b32 v8, v108, s35, 1
    ds_add_rtn_u32 v116, v122, v8 offset:0
    v_and_b32 v108, 0xffff, v108
    v_and_b32 v109, s35, v109
    s_mov_b64 exec, s[82:83]
    v_and_b32 v123, 0x1fc, v111
    v_and_or_b32 v8, v110, s35, 1
    ds_add_rtn_u32 v117, v123, v8 offset:0
    v_and_b32 v110, 0xffff, v110
    v_and_b32 v111, s35, v111
K2A_HISTDONE:
    s_mov_b64 exec, -1
    s_waitcnt lgkmcnt(0)
    s_barrier
    s_cmp_lg_u32 s3, 9
    s_cbranch_scc1 K2A_FRDONE
    s_setprio 3
    v_lshlrev_b32 v8, 2, v1
    ds_read_b32 v78, v8 offset:0
    ds_read_b32 v79, v8 offset:256
    v_mov_b32 v9, 1
    v_mul_u32_u24 v80, 480, v1
    v_add_u32 v80, 6656, v80
    v_add_u32 v4, 30720, v80
    v_mul_u32_u24 v82, 1040, v1
    v_add_u32 v82, 56064, v82
    v_add_u32 v6, 66560, v82
    s_waitcnt lgkmcnt(0)
    v_and_b32 v81, 0xffff, v78
    v_and_b32 v5, 0xffff, v79
    v_min_u32 v73, 63, v81
    v_min_u32 v74, 63, v5
    v_sub_u32 v73, 63, v73
    v_sub_u32 v74, 63, v74
    v_lshlrev_b32 v73, 2, v73
    v_lshlrev_b32 v74, 2, v74
    ds_add_rtn_u32 v75, v73, v9 offset:512
    s_mov_b32 exec_hi, 0xf
    ds_add_rtn_u32 v76, v74, v9 offset:512
    s_mov_b64 exec, -1
    ds_read_b32 v77, v8 offset:512
    ds_write_b32 v8, v81 offset:768
    ds_write_b32 v8, v5 offset:1024
    v_max_u32 v72, v81, v5
    v_cmp_lt_u32 vcc, 60, v72
    v_mov_b32 v71, 0
    s_mov_b64 exec, vcc
    ds_max_u32 v71, v72 offset:4424
    s_mov_b64 exec, -1
    v_lshrrev_b32 v83, 16, v78
    v_lshrrev_b32 v7, 16, v79
    s_waitcnt lgkmcnt(3)
    v_mov_b32 v72, v77
    s_nop 1
    v_add_u32_dpp v72, v72, v72 row_shr:1 row_mask:0xf bank_mask:0xf
    s_nop 1
    v_add_u32_dpp v72, v72, v72 row_shr:2 row_mask:0xf bank_mask:0xf
    s_nop 1
    v_add_u32_dpp v72, v72, v72 row_shr:4 row_mask:0xf bank_mask:0xf
    s_nop 1
    v_add_u32_dpp v72, v72, v72 row_shr:8 row_mask:0xf bank_mask:0xf
    s_nop 1
    v_add_u32_dpp v72, v72, v72 row_bcast:15 row_mask:0xa bank_mask:0xf
    s_nop 1
    v_add_u32_dpp v72, v72, v72 row_bcast:31 row_mask:0xc bank_mask:0xf
    v_sub_u32 v72, v72, v77
    ds_bpermute_b32 v73, v73, v72
    ds_bpermute_b32 v74, v74, v72
    s_waitcnt lgkmcnt(0)
    v_add_lshl_u32 v73, v73, v75, 4
    v_add_lshl_u32 v74, v74, v76, 4
    ds_write_b128 v73, v[80:83] offset:2816
    s_mov_b32 exec_hi, 0xf
    ds_write_b128 v74, v[4:7] offset:2816
    s_mov_b64 exec, -1
    s_setprio 0
K2A_FRDONE:
    s_movk_i32 s24, 120
    s_mov_b64 exec, s[72:73]
    v_min_u16 v8, 59, v112
    v_mul_u32_u24 v9, s24, v118
    v_mad_u32_u16 v9, v8, 8, v9
    ds_write_b64 v9, v[100:101] offset:6656
    s_mov_b64 exec, s[74:75]
    v_min_u16 v8, 59, v113
    v_mul_u32_u24 v9, s24, v119
    v_mad_u32_u16 v9, v8, 8, v9
    ds_write_b64 v9, v[102:103] offset:6656
    s_mov_b64 exec, s[76:77]
    s_cbranch_execz K2A_FSDONE
    v_min_u16 v8, 59, v114
    v_mul_u32_u24 v9, s24, v120
    v_mad_u32_u16 v9, v8, 8, v9
    ds_write_b64 v9, v[104:105] offset:6656
    s_mov_b64 exec, s[78:79]
    v_min_u16 v8, 59, v115
    v_mul_u32_u24 v9, s24, v121
    v_mad_u32_u16 v9, v8, 8, v9
    ds_write_b64 v9, v[106:107] offset:6656
    s_mov_b64 exec, s[80:81]
    s_cbranch_execz K2A_FSDONE
    v_min_u16 v8, 59, v116
    v_mul_u32_u24 v9, s24, v122
    v_mad_u32_u16 v9, v8, 8, v9
    ds_write_b64 v9, v[108:109] offset:6656
    s_mov_b64 exec, s[82:83]
    v_min_u16 v8, 59, v117
    v_mul_u32_u24 v9, s24, v123
    v_mad_u32_u16 v9, v8, 8, v9
    ds_write_b64 v9, v[110:111] offset:6656
K2A_FSDONE:
    s_mov_b64 exec, -1
    s_cmp_lg_u32 s3, 15
    s_cbranch_scc1 K2_PB_OK
    v_mov_b32 v86, 0
    s_mov_b64 exec, 1
    s_mov_b32 s24, 40000
K2_PB_SPIN:
    buffer_load_dwordx2 v[84:85], v86, s[48:51], s64 offen offset:8 sc1
    s_sub_u32 s24, s24, 1
    s_waitcnt vmcnt(0)
    v_cmp_eq_u32 vcc, s62, v84
    v_cmp_eq_u32 s[28:29], s63, v85
    s_or_b64 vcc, vcc, s[28:29]
    s_cbranch_vccz K2_PB_DONE
    s_sleep 1
    s_cmp_lg_u32 s24, 0
    s_cbranch_scc1 K2_PB_SPIN
    v_mov_b32 v84, 1
    ds_write_b32 v86, v84 offset:4436
    s_waitcnt lgkmcnt(0)
K2_PB_DONE:
    s_mov_b64 exec, -1
K2_PB_OK:
    s_mov_b32 s52, s22
    s_and_b32 s53, s23, 0xffff
    s_or_b32 s53, s53, 0x1000000
    s_mov_b32 s54, 25000
    s_mov_b32 s55, 0x00020000
    v_mov_b32 v4, 0
    s_mov_b32 s69, 1
    v_lshlrev_b32 v5, 4, v1
    s_mov_b32 s24, 33161216
    s_waitcnt lgkmcnt(0)
    s_barrier
    buffer_load_dwordx4 v[36:39], v5, s[48:51], s24 offen sc1
    ds_read_b128 v[8:11], v4 offset:4416
    ds_read_b32 v12, v4 offset:4436
    s_lshl_b32 s24, s3, 6
    v_lshl_add_u32 v52, v3, 4, s24
    ds_read_b128 v[52:55], v52 offset:2816
    s_mov_b32 s25, 0
    s_mov_b32 s32, 0
    s_waitcnt lgkmcnt(1)
    v_or_b32 v6, v10, v11
    v_readfirstlane_b32 s28, v12
    v_readfirstlane_b32 s24, v6
    s_cmp_lg_u32 s28, 0
    s_cbranch_scc1 K2_END
    s_cmp_lg_u32 s24, 0
    s_cbranch_scc1 K2_SLOW0
    v_lshlrev_b32 v56, 4, v2
    v_mov_b32 v58, 2816
    v_lshl_add_u32 v58, v3, 4, v58
    v_add_u32 v59, 4480, v56
    s_mov_b32 s33, 0x00003f80
    s_cmp_lt_u32 s3, 16
    s_cselect_b32 s27, s3, 50
    v_mov_b32 v117, v56
    v_mov_b32 v119, v56
    v_mov_b32 v121, v56
    v_mov_b32 v123, v56
    s_waitcnt lgkmcnt(0)
    v_mov_b32 v57, v9
    ds_read_b128 v[28:31], v59
    ds_read_b128 v[32:35], v59 offset:256
    ds_read_b32 v116, v52 offset:0
    ds_read_b32 v118, v52 offset:8
    ds_read_b32 v120, v52 offset:16
    ds_read_b32 v122, v52 offset:24
    ds_read_b32 v124, v52 offset:4
    v_add3_u32 v54, v54, s25, v56
    v_readlane_b32 s29, v53, 0
    v_readlane_b32 s30, v53, 48
    v_readlane_b32 s35, v53, 16
    v_readlane_b32 s71, v53, 32
    ds_read_b128 v[20:23], v54
    ds_read_b128 v[24:27], v54 offset:256
    s_waitcnt lgkmcnt(6)
    buffer_load_dwordx4 v[100:103], v[116:117], s[52:55], s32 idxen offen sc1
    s_waitcnt lgkmcnt(5)
    buffer_load_dwordx4 v[104:107], v[118:119], s[52:55], s32 idxen offen sc1
    s_waitcnt lgkmcnt(4)
    buffer_load_dwordx4 v[108:111], v[120:121], s[52:55], s32 idxen offen sc1
    s_waitcnt lgkmcnt(3)
    buffer_load_dwordx4 v[112:115], v[122:123], s[52:55], s32 idxen offen sc1
    ds_read_b32 v116, v52 offset:32
    s_waitcnt vmcnt(4)
    v_max3_f32 v36, v36, v37, v38
    v_max_f32 v36, v36, v39
    s_nop 1
    v_max_f32_dpp v36, v36, v36 row_shr:1 row_mask:0xf bank_mask:0xf
    s_nop 1
    v_max_f32_dpp v36, v36, v36 row_shr:2 row_mask:0xf bank_mask:0xf
    s_nop 1
    v_max_f32_dpp v36, v36, v36 row_shr:4 row_mask:0xf bank_mask:0xf
    s_nop 1
    v_max_f32_dpp v36, v36, v36 row_shr:8 row_mask:0xf bank_mask:0xf
    s_nop 1
    v_max_f32_dpp v36, v36, v36 row_bcast:15 row_mask:0xa bank_mask:0xf
    s_nop 1
    v_max_f32_dpp v36, v36, v36 row_bcast:31 row_mask:0xc bank_mask:0xf
    s_nop 0
    v_readlane_b32 s34, v36, 63
    s_nop 1
    v_add_f32 v57, s34, v57
    v_fma_f32 v57, v57, 4.0, 4.0
    s_branch K2_GO
K2_SLOW0:
    s_waitcnt vmcnt(0)
    v_max3_f32 v36, v36, v37, v38
    v_max_f32 v36, v36, v39
    s_nop 1
    v_max_f32_dpp v36, v36, v36 row_shr:1 row_mask:0xf bank_mask:0xf
    s_nop 1
    v_max_f32_dpp v36, v36, v36 row_shr:2 row_mask:0xf bank_mask:0xf
    s_nop 1
    v_max_f32_dpp v36, v36, v36 row_shr:4 row_mask:0xf bank_mask:0xf
    s_nop 1
    v_max_f32_dpp v36, v36, v36 row_shr:8 row_mask:0xf bank_mask:0xf
    s_nop 1
    v_max_f32_dpp v36, v36, v36 row_bcast:15 row_mask:0xa bank_mask:0xf
    s_nop 1
    v_max_f32_dpp v36, v36, v36 row_bcast:31 row_mask:0xc bank_mask:0xf
    s_nop 0
    v_readlane_b32 s34, v36, 63
    v_lshrrev_b32 v6, 2, v0
    v_lshlrev_b32 v7, 10, v6
    s_lshl_b32 s24, s2, 2
    s_add_u32 s24, s24, 32833536
    v_mul_u32_u24 v126, 12544, v6
    v_cmp_lt_u32 vcc, 24, v124
    s_mov_b32 s70, 29622272
    s_mov_b64 exec, vcc
    buffer_load_dword v6, v7, s[48:51], s24 offen sc1
    s_waitcnt vmcnt(0)
    v_lshrrev_b32 v124, 16, v6
    v_and_b32 v6, 0xffff, v6
    v_add_u32 v6, v6, v127
    v_lshl_add_u32 v126, v6, 3, v126
    ds_max_u32 v4, v124 offset:4428
    s_mov_b64 exec, -1
    v_sub_u32 v127, v124, v127
    s_sub_u32 s24, s3, 8
    s_cmp_ge_u32 s24, 2
    s_cbranch_scc1 K2S_SRDONE
    v_lshlrev_b32 v8, 2, v1
    ds_read_b32 v78, v8 offset:0
    ds_read_b32 v79, v8 offset:256
    v_mov_b32 v9, 1
    s_waitcnt lgkmcnt(0)
    v_and_b32 v68, 0xffff, v78
    v_and_b32 v69, 0xffff, v79
    s_cmp_eq_u32 s3, 8
    s_cbranch_scc1 K2S_SCAN
    v_mov_b32 v77, 0
    ds_write_b32 v8, v77 offset:512
    v_min_u32 v73, 63, v68
    v_min_u32 v74, 63, v69
    v_sub_u32 v73, 63, v73
    v_sub_u32 v74, 63, v74
    v_lshlrev_b32 v73, 2, v73
    v_lshlrev_b32 v74, 2, v74
    ds_add_rtn_u32 v75, v73, v9 offset:512
    s_mov_b32 exec_hi, 0xf
    ds_add_rtn_u32 v76, v74, v9 offset:512
    s_mov_b64 exec, -1
    ds_read_b32 v77, v8 offset:512
    s_waitcnt lgkmcnt(0)
K2S_SCAN:
    v_mov_b32 v70, v68
    v_mov_b32 v71, v69
    v_mov_b32 v72, v77
    s_nop 0
    v_add_u32_dpp v70, v70, v70 row_shr:1 row_mask:0xf bank_mask:0xf
    v_add_u32_dpp v71, v71, v71 row_shr:1 row_mask:0xf bank_mask:0xf
    v_add_u32_dpp v72, v72, v72 row_shr:1 row_mask:0xf bank_mask:0xf
    s_nop 0
    v_add_u32_dpp v70, v70, v70 row_shr:2 row_mask:0xf bank_mask:0xf
    v_add_u32_dpp v71, v71, v71 row_shr:2 row_mask:0xf bank_mask:0xf
    v_add_u32_dpp v72, v72, v72 row_shr:2 row_mask:0xf bank_mask:0xf
    s_nop 0
    v_add_u32_dpp v70, v70, v70 row_shr:4 row_mask:0xf bank_mask:0xf
    v_add_u32_dpp v71, v71, v71 row_shr:4 row_mask:0xf bank_mask:0xf
    v_add_u32_dpp v72, v72, v72 row_shr:4 row_mask:0xf bank_mask:0xf
    s_nop 0
    v_add_u32_dpp v70, v70, v70 row_shr:8 row_mask:0xf bank_mask:0xf
    v_add_u32_dpp v71, v71, v71 row_shr:8 row_mask:0xf bank_mask:0xf
    v_add_u32_dpp v72, v72, v72 row_shr:8 row_mask:0xf bank_mask:0xf
    s_nop 0
    v_add_u32_dpp v70, v70, v70 row_bcast:15 row_mask:0xa bank_mask:0xf
    v_add_u32_dpp v71, v71, v71 row_bcast:15 row_mask:0xa bank_mask:0xf
    v_add_u32_dpp v72, v72, v72 row_bcast:15 row_mask:0xa bank_mask:0xf
    s_nop 0
    v_add_u32_dpp v70, v70, v70 row_bcast:31 row_mask:0xc bank_mask:0xf
    v_add_u32_dpp v71, v71, v71 row_bcast:31 row_mask:0xc bank_mask:0xf
    v_add_u32_dpp v72, v72, v72 row_bcast:31 row_mask:0xc bank_mask:0xf
    v_mov_b32 v9, 6656
    v_readlane_b32 s24, v70, 63
    v_sub_u32 v70, v70, v68
    v_sub_u32 v71, v71, v69
    v_add_u32 v71, s24, v71
    v_lshl_add_u32 v80, v70, 3, v9
    v_lshl_add_u32 v4, v71, 3, v9
    s_cmp_eq_u32 s3, 8
    s_cbranch_scc0 K2S_RANK
    ds_write_b32 v8, v80 offset:2304
    ds_write_b32 v8, v4 offset:2560
    s_branch K2S_SRDONE
K2S_RANK:
    v_sub_u32 v72, v72, v77
    ds_bpermute_b32 v73, v73, v72
    ds_bpermute_b32 v74, v74, v72
    v_mov_b32 v81, v68
    v_mul_u32_u24 v82, 1040, v1
    v_add_u32 v82, 56064, v82
    v_lshrrev_b32 v83, 16, v78
    v_mov_b32 v5, v69
    v_add_u32 v6, 66560, v82
    v_lshrrev_b32 v7, 16, v79
    s_waitcnt lgkmcnt(0)
    v_add_lshl_u32 v73, v73, v75, 4
    v_add_lshl_u32 v74, v74, v76, 4
    ds_write_b128 v73, v[80:83] offset:2816
    s_mov_b32 exec_hi, 0xf
    ds_write_b128 v74, v[4:7] offset:2816
    s_mov_b64 exec, -1
K2S_SRDONE:
    s_waitcnt lgkmcnt(0)
    s_barrier
    s_mov_b64 exec, s[72:73]
    ds_read_b32 v118, v118 offset:2304
    s_mov_b64 exec, s[74:75]
    ds_read_b32 v119, v119 offset:2304
    s_mov_b64 exec, s[76:77]
    s_cbranch_execz K2S_POSDONE
    ds_read_b32 v120, v120 offset:2304
    s_mov_b64 exec, s[78:79]
    ds_read_b32 v121, v121 offset:2304
    s_mov_b64 exec, s[80:81]
    s_cbranch_execz K2S_POSDONE
    ds_read_b32 v122, v122 offset:2304
    s_mov_b64 exec, s[82:83]
    ds_read_b32 v123, v123 offset:2304
K2S_POSDONE:
    s_mov_b64 exec, -1
    s_waitcnt lgkmcnt(0)
    s_mov_b64 exec, s[72:73]
    v_mad_u32_u16 v118, v112, 8, v118
    ds_write_b64 v118, v[100:101]
    s_mov_b64 exec, s[74:75]
    v_mad_u32_u16 v119, v113, 8, v119
    ds_write_b64 v119, v[102:103]
    s_mov_b64 exec, s[76:77]
    s_cbranch_execz K2S_SCATDONE
    v_mad_u32_u16 v120, v114, 8, v120
    ds_write_b64 v120, v[104:105]
    s_mov_b64 exec, s[78:79]
    v_mad_u32_u16 v121, v115, 8, v121
    ds_write_b64 v121, v[106:107]
    s_mov_b64 exec, s[80:81]
    s_cbranch_execz K2S_SCATDONE
    v_mad_u32_u16 v122, v116, 8, v122
    ds_write_b64 v122, v[108:109]
    s_mov_b64 exec, s[82:83]
    v_mad_u32_u16 v123, v117, 8, v123
    ds_write_b64 v123, v[110:111]
K2S_SCATDONE:
    s_mov_b64 exec, -1
    s_branch K2_MAIN
K2_BATCH:
    s_waitcnt vmcnt(0)
    s_mov_b32 s35, 0xffff0000
    s_mov_b64 exec, s[72:73]
    v_and_b32 v118, 0x1fc, v101
    v_and_or_b32 v8, v100, s35, 1
    ds_add_rtn_u32 v112, v118, v8 offset:0
    v_and_b32 v100, 0xffff, v100
    v_and_b32 v101, s35, v101
    s_mov_b64 exec, s[74:75]
    v_and_b32 v119, 0x1fc, v103
    v_and_or_b32 v8, v102, s35, 1
    ds_add_rtn_u32 v113, v119, v8 offset:0
    v_and_b32 v102, 0xffff, v102
    v_and_b32 v103, s35, v103
    s_mov_b64 exec, s[76:77]
    s_cbranch_execz K2B_HISTDONE
    v_and_b32 v120, 0x1fc, v105
    v_and_or_b32 v8, v104, s35, 1
    ds_add_rtn_u32 v114, v120, v8 offset:0
    v_and_b32 v104, 0xffff, v104
    v_and_b32 v105, s35, v105
    s_mov_b64 exec, s[78:79]
    v_and_b32 v121, 0x1fc, v107
    v_and_or_b32 v8, v106, s35, 1
    ds_add_rtn_u32 v115, v121, v8 offset:0
    v_and_b32 v106, 0xffff, v106
    v_and_b32 v107, s35, v107
    s_mov_b64 exec, s[80:81]
    s_cbranch_execz K2B_HISTDONE
    v_and_b32 v122, 0x1fc, v109
    v_and_or_b32 v8, v108, s35, 1
    ds_add_rtn_u32 v116, v122, v8 offset:0
    v_and_b32 v108, 0xffff, v108
    v_and_b32 v109, s35, v109
    s_mov_b64 exec, s[82:83]
    v_and_b32 v123, 0x1fc, v111
    v_and_or_b32 v8, v110, s35, 1
    ds_add_rtn_u32 v117, v123, v8 offset:0
    v_and_b32 v110, 0xffff, v110
    v_and_b32 v111, s35, v111
K2B_HISTDONE:
    s_mov_b64 exec, -1
    s_waitcnt lgkmcnt(0)
    s_barrier
    s_sub_u32 s24, s3, 8
    s_cmp_ge_u32 s24, 2
    s_cbranch_scc1 K2B_SRDONE
    v_lshlrev_b32 v8, 2, v1
    ds_read_b32 v78, v8 offset:0
    ds_read_b32 v79, v8 offset:256
    v_mov_b32 v9, 1
    s_waitcnt lgkmcnt(0)
    v_and_b32 v68, 0xffff, v78
    v_and_b32 v69, 0xffff, v79
    s_cmp_eq_u32 s3, 8
    s_cbranch_scc1 K2B_SCAN
    v_mov_b32 v77, 0
    ds_write_b32 v8, v77 offset:512
    v_min_u32 v73, 63, v68
    v_min_u32 v74, 63, v69
    v_sub_u32 v73, 63, v73
    v_sub_u32 v74, 63, v74
    v_lshlrev_b32 v73, 2, v73
    v_lshlrev_b32 v74, 2, v74
    ds_add_rtn_u32 v75, v73, v9 offset:512
    s_mov_b32 exec_hi, 0xf
    ds_add_rtn_u32 v76, v74, v9 offset:512
    s_mov_b64 exec, -1
    ds_read_b32 v77, v8 offset:512
    s_waitcnt lgkmcnt(0)
K2B_SCAN:
    v_mov_b32 v70, v68
    v_mov_b32 v71, v69
    v_mov_b32 v72, v77
    s_nop 0
    v_add_u32_dpp v70, v70, v70 row_shr:1 row_mask:0xf bank_mask:0xf
    v_add_u32_dpp v71, v71, v71 row_shr:1 row_mask:0xf bank_mask:0xf
    v_add_u32_dpp v72, v72, v72 row_shr:1 row_mask:0xf bank_mask:0xf
    s_nop 0
    v_add_u32_dpp v70, v70, v70 row_shr:2 row_mask:0xf bank_mask:0xf
    v_add_u32_dpp v71, v71, v71 row_shr:2 row_mask:0xf bank_mask:0xf
    v_add_u32_dpp v72, v72, v72 row_shr:2 row_mask:0xf bank_mask:0xf
    s_nop 0
    v_add_u32_dpp v70, v70, v70 row_shr:4 row_mask:0xf bank_mask:0xf
    v_add_u32_dpp v71, v71, v71 row_shr:4 row_mask:0xf bank_mask:0xf
    v_add_u32_dpp v72, v72, v72 row_shr:4 row_mask:0xf bank_mask:0xf
    s_nop 0
    v_add_u32_dpp v70, v70, v70 row_shr:8 row_mask:0xf bank_mask:0xf
    v_add_u32_dpp v71, v71, v71 row_shr:8 row_mask:0xf bank_mask:0xf
    v_add_u32_dpp v72, v72, v72 row_shr:8 row_mask:0xf bank_mask:0xf
    s_nop 0
    v_add_u32_dpp v70, v70, v70 row_bcast:15 row_mask:0xa bank_mask:0xf
    v_add_u32_dpp v71, v71, v71 row_bcast:15 row_mask:0xa bank_mask:0xf
    v_add_u32_dpp v72, v72, v72 row_bcast:15 row_mask:0xa bank_mask:0xf
    s_nop 0
    v_add_u32_dpp v70, v70, v70 row_bcast:31 row_mask:0xc bank_mask:0xf
    v_add_u32_dpp v71, v71, v71 row_bcast:31 row_mask:0xc bank_mask:0xf
    v_add_u32_dpp v72, v72, v72 row_bcast:31 row_mask:0xc bank_mask:0xf
    v_mov_b32 v9, 6656
    v_readlane_b32 s24, v70, 63
    v_sub_u32 v70, v70, v68
    v_sub_u32 v71, v71, v69
    v_add_u32 v71, s24, v71
    v_lshl_add_u32 v80, v70, 3, v9
    v_lshl_add_u32 v4, v71, 3, v9
    s_cmp_eq_u32 s3, 8
    s_cbranch_scc0 K2B_RANK
    ds_write_b32 v8, v80 offset:2304
    ds_write_b32 v8, v4 offset:2560
    ds_add_u32 v8, v68 offset:768
    ds_add_u32 v8, v69 offset:1024
    s_branch K2B_SRDONE
K2B_RANK:
    v_sub_u32 v72, v72, v77
    ds_bpermute_b32 v73, v73, v72
    ds_bpermute_b32 v74, v74, v72
    v_mov_b32 v81, v68
    v_mul_u32_u24 v82, 1040, v1
    v_add_u32 v82, 56064, v82
    v_lshrrev_b32 v83, 16, v78
    v_mov_b32 v5, v69
    v_add_u32 v6, 66560, v82
    v_lshrrev_b32 v7, 16, v79
    s_waitcnt lgkmcnt(0)
    v_add_lshl_u32 v73, v73, v75, 4
    v_add_lshl_u32 v74, v74, v76, 4
    ds_write_b128 v73, v[80:83] offset:2816
    s_mov_b32 exec_hi, 0xf
    ds_write_b128 v74, v[4:7] offset:2816
    s_mov_b64 exec, -1
K2B_SRDONE:
    s_waitcnt lgkmcnt(0)
    s_barrier
    s_mov_b64 exec, s[72:73]
    ds_read_b32 v118, v118 offset:2304
    s_mov_b64 exec, s[74:75]
    ds_read_b32 v119, v119 offset:2304
    s_mov_b64 exec, s[76:77]
    s_cbranch_execz K2B_POSDONE
    ds_read_b32 v120, v120 offset:2304
    s_mov_b64 exec, s[78:79]
    ds_read_b32 v121, v121 offset:2304
    s_mov_b64 exec, s[80:81]
    s_cbranch_execz K2B_POSDONE
    ds_read_b32 v122, v122 offset:2304
    s_mov_b64 exec, s[82:83]
    ds_read_b32 v123, v123 offset:2304
K2B_POSDONE:
    s_mov_b64 exec, -1
    s_waitcnt lgkmcnt(0)
    s_mov_b64 exec, s[72:73]
    v_mad_u32_u16 v118, v112, 8, v118
    ds_write_b64 v118, v[100:101]
    s_mov_b64 exec, s[74:75]
    v_mad_u32_u16 v119, v113, 8, v119
    ds_write_b64 v119, v[102:103]
    s_mov_b64 exec, s[76:77]
    s_cbranch_execz K2B_SCATDONE
    v_mad_u32_u16 v120, v114, 8, v120
    ds_write_b64 v120, v[104:105]
    s_mov_b64 exec, s[78:79]
    v_mad_u32_u16 v121, v115, 8, v121
    ds_write_b64 v121, v[106:107]
    s_mov_b64 exec, s[80:81]
    s_cbranch_execz K2B_SCATDONE
    v_mad_u32_u16 v122, v116, 8, v122
    ds_write_b64 v122, v[108:109]
    s_mov_b64 exec, s[82:83]
    v_mad_u32_u16 v123, v117, 8, v123
    ds_write_b64 v123, v[110:111]
K2B_SCATDONE:
    s_mov_b64 exec, -1
K2_MAIN:
    v_mov_b32 v4, 0
    s_waitcnt lgkmcnt(0)
    s_barrier
    ds_read_b128 v[52:55], v4 offset:4416
    v_lshlrev_b32 v56, 4, v2
    v_mov_b32 v58, 2816
    v_lshl_add_u32 v58, v3, 4, v58
    v_add_u32 v59, 4480, v56
    s_mov_b32 s33, 0x00003f80
    s_cmp_lt_u32 s3, 16
    s_cselect_b32 s27, s3, 50
    v_mov_b32 v117, v56
    v_mov_b32 v119, v56
    v_mov_b32 v121, v56
    v_mov_b32 v123, v56
    s_waitcnt lgkmcnt(0)
    v_readfirstlane_b32 s24, v55
    v_add_f32 v57, s34, v53
    v_fma_f32 v57, v57, 4.0, 4.0
    s_add_u32 s24, s24, 23
    s_mul_i32 s24, s24, 2731
    s_lshr_b32 s69, s24, 16
    s_cmp_le_u32 s69, 1
    s_cbranch_scc1 K2_ITEM
    v_mov_b32 v57, 0x7f800000
K2_ITEM:
    s_cmp_ge_u32 s27, 50
    s_cbranch_scc1 K2_DONE
    s_cmp_ge_u32 s27, 25
    s_cselect_b32 s24, 25, 0
    s_cselect_b32 s25, 512, 0
    s_cselect_b32 s32, 6400000, 0
    s_sub_u32 s24, s27, s24
    s_lshl_b32 s24, s24, 6
    v_add_u32 v61, s24, v58
    ds_read_b128 v[52:55], v61
    v_add_u32 v61, s25, v59
    ds_read_b128 v[28:31], v61
    ds_read_b128 v[32:35], v61 offset:256
    s_mov_b32 s54, 25000
    s_waitcnt lgkmcnt(2)
    ds_read_b32 v116, v52 offset:0
    ds_read_b32 v118, v52 offset:8
    ds_read_b32 v120, v52 offset:16
    ds_read_b32 v122, v52 offset:24
    ds_read_b32 v124, v52 offset:4
    v_add3_u32 v54, v54, s25, v56
    v_readlane_b32 s29, v53, 0
    v_readlane_b32 s30, v53, 48
    v_readlane_b32 s35, v53, 16
    v_readlane_b32 s71, v53, 32
    ds_read_b128 v[20:23], v54
    ds_read_b128 v[24:27], v54 offset:256
    s_waitcnt lgkmcnt(6)
    buffer_load_dwordx4 v[100:103], v[116:117], s[52:55], s32 idxen offen sc1
    s_waitcnt lgkmcnt(5)
    buffer_load_dwordx4 v[104:107], v[118:119], s[52:55], s32 idxen offen sc1
    s_waitcnt lgkmcnt(4)
    buffer_load_dwordx4 v[108:111], v[120:121], s[52:55], s32 idxen offen sc1
    s_waitcnt lgkmcnt(3)
    buffer_load_dwordx4 v[112:115], v[122:123], s[52:55], s32 idxen offen sc1
    ds_read_b32 v116, v52 offset:32
K2_GO:
    v_cvt_f32_u32 v61, v53
    v_cvt_f32_u32 v55, v55
    v_fma_f32 v61, v61, v57, v55
    s_max_u32 s24, s29, s30
    s_min_u32 s30, s29, s30
    v_cmp_nge_f32 vcc, 0x43e00000, v61
    s_max_u32 s29, s35, s71
    s_min_u32 s35, s35, s71
    s_max_u32 s29, s29, s24
    s_min_u32 s30, s30, s35
    s_min_u32 s29, s29, 6144
    s_sub_u32 s31, s29, 4
    s_cmp_gt_i32 s31, 0
    s_cselect_b32 s54, 25000, 0
    s_mov_b32 s28, 0
    s_setprio 0
    s_cbranch_vccnz K2_P_START
    s_cmp_lg_u32 s30, 0
    s_cbranch_scc1 K2_F_FIRST
    v_mov_b32 v64, 0
    v_mov_b32 v72, 1.0
    v_mov_b32 v65, 0
    v_mov_b32 v73, 1.0
    v_mov_b32 v66, 0
    v_mov_b32 v74, 1.0
    v_mov_b32 v67, 0
    v_mov_b32 v75, 1.0
    v_mov_b32 v68, 0
    v_mov_b32 v76, 1.0
    v_mov_b32 v69, 0
    v_mov_b32 v77, 1.0
    v_mov_b32 v70, 0
    v_mov_b32 v78, 1.0
    v_mov_b32 v71, 0
    v_mov_b32 v79, 1.0
    s_cmp_eq_u32 s29, 0
    s_cbranch_scc1 K2_F_FLUSH
    v_cmpx_lt_u32 vcc, 0, v53
K2_F_FIRST:
    s_waitcnt lgkmcnt(0)
    v_pk_fma_f32 v[64:65], v[28:29], v[124:125], v[20:21] op_sel_hi:[1,0,1]
    v_pk_fma_f32 v[66:67], v[30:31], v[124:125], v[22:23] op_sel_hi:[1,0,1]
    v_pk_fma_f32 v[68:69], v[32:33], v[124:125], v[24:25] op_sel_hi:[1,0,1]
    v_pk_fma_f32 v[70:71], v[34:35], v[124:125], v[26:27] op_sel_hi:[1,0,1]
    ds_read_b32 v125, v52 offset:12
    s_waitcnt vmcnt(3)
    v_dot2_f32_bf16 v64, v100, s33, v64
    v_dot2_f32_bf16 v65, v101, s33, v65
    v_dot2_f32_bf16 v66, v102, s33, v66
    v_dot2_f32_bf16 v67, v103, s33, v67
    v_pk_add_f32 v[68:69], v[100:101], v[68:69]
    v_pk_add_f32 v[70:71], v[102:103], v[70:71]
    buffer_load_dwordx4 v[100:103], v[116:117], s[52:55], s32 idxen offen sc1
    ds_read_b32 v118, v52 offset:40
    s_add_u32 s28, s28, 1
    s_cmp_lt_i32 s28, s31
    s_cselect_b32 s54, 25000, 0
    s_cmp_ge_u32 s28, s30
    v_exp_f32 v48, v68
    v_exp_f32 v49, v69
    v_exp_f32 v50, v70
    v_exp_f32 v51, v71
    v_exp_f32 v44, v64
    v_exp_f32 v45, v65
    v_exp_f32 v46, v66
    v_exp_f32 v47, v67
    v_pk_add_f32 v[76:77], v[48:49], 1.0 op_sel_hi:[1,0]
    v_pk_add_f32 v[78:79], v[50:51], 1.0 op_sel_hi:[1,0]
    v_pk_add_f32 v[72:73], v[44:45], 1.0 op_sel_hi:[1,0]
    v_pk_add_f32 v[74:75], v[46:47], 1.0 op_sel_hi:[1,0]
    s_cbranch_scc1 K2_F_T0
K2_F_S1:
    s_waitcnt lgkmcnt(0)
    v_pk_fma_f32 v[36:37], v[28:29], v[124:125], v[20:21] op_sel:[0,1,0] op_sel_hi:[1,1,1]
    v_pk_fma_f32 v[38:39], v[30:31], v[124:125], v[22:23] op_sel:[0,1,0] op_sel_hi:[1,1,1]
    v_pk_fma_f32 v[40:41], v[32:33], v[124:125], v[24:25] op_sel:[0,1,0] op_sel_hi:[1,1,1]
    v_pk_fma_f32 v[42:43], v[34:35], v[124:125], v[26:27] op_sel:[0,1,0] op_sel_hi:[1,1,1]
    ds_read_b32 v124, v52 offset:20
    s_waitcnt vmcnt(3)
    v_dot2_f32_bf16 v36, v104, s33, v36
    v_dot2_f32_bf16 v37, v105, s33, v37
    v_dot2_f32_bf16 v38, v106, s33, v38
    v_dot2_f32_bf16 v39, v107, s33, v39
    v_pk_add_f32 v[40:41], v[104:105], v[40:41]
    v_pk_add_f32 v[42:43], v[106:107], v[42:43]
    buffer_load_dwordx4 v[104:107], v[118:119], s[52:55], s32 idxen offen sc1
    ds_read_b32 v120, v52 offset:48
    s_add_u32 s28, s28, 1
    s_cmp_lt_i32 s28, s31
    s_cselect_b32 s54, 25000, 0
    s_cmp_ge_u32 s28, s30
    v_exp_f32 v48, v40
    v_exp_f32 v49, v41
    v_exp_f32 v50, v42
    v_exp_f32 v51, v43
    v_exp_f32 v44, v36
    v_exp_f32 v45, v37
    v_exp_f32 v46, v38
    v_exp_f32 v47, v39
    v_pk_fma_f32 v[68:69], v[68:69], v[48:49], v[68:69]
    v_pk_fma_f32 v[70:71], v[70:71], v[50:51], v[70:71]
    v_pk_fma_f32 v[64:65], v[64:65], v[44:45], v[64:65]
    v_pk_fma_f32 v[66:67], v[66:67], v[46:47], v[66:67]
    v_pk_fma_f32 v[68:69], v[40:41], v[76:77], v[68:69]
    v_pk_fma_f32 v[70:71], v[42:43], v[78:79], v[70:71]
    v_pk_fma_f32 v[64:65], v[36:37], v[72:73], v[64:65]
    v_pk_fma_f32 v[66:67], v[38:39], v[74:75], v[66:67]
    v_pk_fma_f32 v[76:77], v[76:77], v[48:49], v[76:77]
    v_pk_fma_f32 v[78:79], v[78:79], v[50:51], v[78:79]
    v_pk_fma_f32 v[72:73], v[72:73], v[44:45], v[72:73]
    v_pk_fma_f32 v[74:75], v[74:75], v[46:47], v[74:75]
    s_cbranch_scc1 K2_F_T1
K2_F_S2:
    s_waitcnt lgkmcnt(0)
    v_pk_fma_f32 v[36:37], v[28:29], v[124:125], v[20:21] op_sel_hi:[1,0,1]
    v_pk_fma_f32 v[38:39], v[30:31], v[124:125], v[22:23] op_sel_hi:[1,0,1]
    v_pk_fma_f32 v[40:41], v[32:33], v[124:125], v[24:25] op_sel_hi:[1,0,1]
    v_pk_fma_f32 v[42:43], v[34:35], v[124:125], v[26:27] op_sel_hi:[1,0,1]
    ds_read_b32 v125, v52 offset:28
    s_waitcnt vmcnt(3)
    v_dot2_f32_bf16 v36, v108, s33, v36
    v_dot2_f32_bf16 v37, v109, s33, v37
    v_dot2_f32_bf16 v38, v110, s33, v38
    v_dot2_f32_bf16 v39, v111, s33, v39
    v_pk_add_f32 v[40:41], v[108:109], v[40:41]
    v_pk_add_f32 v[42:43], v[110:111], v[42:43]
    buffer_load_dwordx4 v[108:111], v[120:121], s[52:55], s32 idxen offen sc1
    ds_read_b32 v122, v52 offset:56
    s_add_u32 s28, s28, 1
    s_cmp_lt_i32 s28, s31
    s_cselect_b32 s54, 25000, 0
    s_cmp_ge_u32 s28, s30
    v_exp_f32 v48, v40
    v_exp_f32 v49, v41
    v_exp_f32 v50, v42
    v_exp_f32 v51, v43
    v_exp_f32 v44, v36
    v_exp_f32 v45, v37
    v_exp_f32 v46, v38
    v_exp_f32 v47, v39
    v_pk_fma_f32 v[68:69], v[68:69], v[48:49], v[68:69]
    v_pk_fma_f32 v[70:71], v[70:71], v[50:51], v[70:71]
    v_pk_fma_f32 v[64:65], v[64:65], v[44:45], v[64:65]
    v_pk_fma_f32 v[66:67], v[66:67], v[46:47], v[66:67]
    v_pk_fma_f32 v[68:69], v[40:41], v[76:77], v[68:69]
    v_pk_fma_f32 v[70:71], v[42:43], v[78:79], v[70:71]
    v_pk_fma_f32 v[64:65], v[36:37], v[72:73], v[64:65]
    v_pk_fma_f32 v[66:67], v[38:39], v[74:75], v[66:67]
    v_pk_fma_f32 v[76:77], v[76:77], v[48:49], v[76:77]
    v_pk_fma_f32 v[78:79], v[78:79], v[50:51], v[78:79]
    v_pk_fma_f32 v[72:73], v[72:73], v[44:45], v[72:73]
    v_pk_fma_f32 v[74:75], v[74:75], v[46:47], v[74:75]
    s_cbranch_scc1 K2_F_T2
K2_F_S3:
    s_waitcnt lgkmcnt(0)
    v_pk_fma_f32 v[36:37], v[28:29], v[124:125], v[20:21] op_sel:[0,1,0] op_sel_hi:[1,1,1]
    v_pk_fma_f32 v[38:39], v[30:31], v[124:125], v[22:23] op_sel:[0,1,0] op_sel_hi:[1,1,1]
    v_pk_fma_f32 v[40:41], v[32:33], v[124:125], v[24:25] op_sel:[0,1,0] op_sel_hi:[1,1,1]
    v_pk_fma_f32 v[42:43], v[34:35], v[124:125], v[26:27] op_sel:[0,1,0] op_sel_hi:[1,1,1]
    ds_read_b32 v124, v52 offset:36
    s_waitcnt vmcnt(3)
    v_dot2_f32_bf16 v36, v112, s33, v36
    v_dot2_f32_bf16 v37, v113, s33, v37
    v_dot2_f32_bf16 v38, v114, s33, v38
    v_dot2_f32_bf16 v39, v115, s33, v39
    v_pk_add_f32 v[40:41], v[112:113], v[40:41]
    v_pk_add_f32 v[42:43], v[114:115], v[42:43]
    buffer_load_dwordx4 v[112:115], v[122:123], s[52:55], s32 idxen offen sc1
    ds_read_b32 v116, v52 offset:64
    s_add_u32 s28, s28, 1
    s_cmp_lt_i32 s28, s31
    s_cselect_b32 s54, 25000, 0
    s_cmp_ge_u32 s28, s30
    v_exp_f32 v48, v40
    v_exp_f32 v49, v41
    v_exp_f32 v50, v42
    v_exp_f32 v51, v43
    v_exp_f32 v44, v36
    v_exp_f32 v45, v37
    v_exp_f32 v46, v38
    v_exp_f32 v47, v39
    v_pk_fma_f32 v[68:69], v[68:69], v[48:49], v[68:69]
    v_pk_fma_f32 v[70:71], v[70:71], v[50:51], v[70:71]
    v_pk_fma_f32 v[64:65], v[64:65], v[44:45], v[64:65]
    v_pk_fma_f32 v[66:67], v[66:67], v[46:47], v[66:67]
    v_pk_fma_f32 v[68:69], v[40:41], v[76:77], v[68:69]
    v_pk_fma_f32 v[70:71], v[42:43], v[78:79], v[70:71]
    v_pk_fma_f32 v[64:65], v[36:37], v[72:73], v[64:65]
    v_pk_fma_f32 v[66:67], v[38:39], v[74:75], v[66:67]
    v_pk_fma_f32 v[76:77], v[76:77], v[48:49], v[76:77]
    v_pk_fma_f32 v[78:79], v[78:79], v[50:51], v[78:79]
    v_pk_fma_f32 v[72:73], v[72:73], v[44:45], v[72:73]
    v_pk_fma_f32 v[74:75], v[74:75], v[46:47], v[74:75]
    v_add_u32 v52, 32, v52
    s_setprio 1
    s_cbranch_scc1 K2_F_T3
K2_F_S0:
    s_waitcnt lgkmcnt(0)
    v_pk_fma_f32 v[36:37], v[28:29], v[124:125], v[20:21] op_sel_hi:[1,0,1]
    v_pk_fma_f32 v[38:39], v[30:31], v[124:125], v[22:23] op_sel_hi:[1,0,1]
    v_pk_fma_f32 v[40:41], v[32:33], v[124:125], v[24:25] op_sel_hi:[1,0,1]
    v_pk_fma_f32 v[42:43], v[34:35], v[124:125], v[26:27] op_sel_hi:[1,0,1]
    ds_read_b32 v125, v52 offset:12
    s_waitcnt vmcnt(3)
    v_dot2_f32_bf16 v36, v100, s33, v36
    v_dot2_f32_bf16 v37, v101, s33, v37
    v_dot2_f32_bf16 v38, v102, s33, v38
    v_dot2_f32_bf16 v39, v103, s33, v39
    v_pk_add_f32 v[40:41], v[100:101], v[40:41]
    v_pk_add_f32 v[42:43], v[102:103], v[42:43]
    buffer_load_dwordx4 v[100:103], v[116:117], s[52:55], s32 idxen offen sc1
    ds_read_b32 v118, v52 offset:40
    s_add_u32 s28, s28, 1
    s_cmp_lt_i32 s28, s31
    s_cselect_b32 s54, 25000, 0
    s_cmp_ge_u32 s28, s30
    v_exp_f32 v48, v40
    v_exp_f32 v49, v41
    v_exp_f32 v50, v42
    v_exp_f32 v51, v43
    v_exp_f32 v44, v36
    v_exp_f32 v45, v37
    v_exp_f32 v46, v38
    v_exp_f32 v47, v39
    v_pk_fma_f32 v[68:69], v[68:69], v[48:49], v[68:69]
    v_pk_fma_f32 v[70:71], v[70:71], v[50:51], v[70:71]
    v_pk_fma_f32 v[64:65], v[64:65], v[44:45], v[64:65]
    v_pk_fma_f32 v[66:67], v[66:67], v[46:47], v[66:67]
    v_pk_fma_f32 v[68:69], v[40:41], v[76:77], v[68:69]
    v_pk_fma_f32 v[70:71], v[42:43], v[78:79], v[70:71]
    v_pk_fma_f32 v[64:65], v[36:37], v[72:73], v[64:65]
    v_pk_fma_f32 v[66:67], v[38:39], v[74:75], v[66:67]
    v_pk_fma_f32 v[76:77], v[76:77], v[48:49], v[76:77]
    v_pk_fma_f32 v[78:79], v[78:79], v[50:51], v[78:79]
    v_pk_fma_f32 v[72:73], v[72:73], v[44:45], v[72:73]
    v_pk_fma_f32 v[74:75], v[74:75], v[46:47], v[74:75]
    s_cbranch_scc0 K2_F_S1
K2_F_T0:
    s_setprio 2
    s_cmp_ge_u32 s28, s29
    s_cbranch_scc1 K2_F_FLUSH
    v_cmpx_lt_u32 vcc, s28, v53
    s_branch K2_F_S1
K2_F_T1:
    s_setprio 2
    s_cmp_ge_u32 s28, s29
    s_cbranch_scc1 K2_F_FLUSH
    v_cmpx_lt_u32 vcc, s28, v53
    s_branch K2_F_S2
K2_F_T2:
    s_setprio 2
    s_cmp_ge_u32 s28, s29
    s_cbranch_scc1 K2_F_FLUSH
    v_cmpx_lt_u32 vcc, s28, v53
    s_branch K2_F_S3
K2_F_T3:
    s_setprio 2
    s_cmp_ge_u32 s28, s29
    s_cbranch_scc1 K2_F_FLUSH
    v_cmpx_lt_u32 vcc, s28, v53
    s_branch K2_F_S0
K2_F_FLUSH:
    s_mov_b64 exec, 1
    v_mov_b32 v60, 0
    v_mov_b32 v61, 1
    ds_add_rtn_u32 v60, v60, v61 offset:4432
    s_mov_b64 exec, -1
    v_rcp_f32 v44, v72
    v_rcp_f32 v45, v73
    v_rcp_f32 v46, v74
    v_rcp_f32 v47, v75
    v_rcp_f32 v48, v76
    v_rcp_f32 v49, v77
    v_rcp_f32 v50, v78
    v_rcp_f32 v51, v79
    v_pk_mul_f32 v[64:65], v[64:65], v[44:45]
    v_pk_mul_f32 v[66:67], v[66:67], v[46:47]
    v_pk_mul_f32 v[68:69], v[68:69], v[48:49]
    v_pk_mul_f32 v[70:71], v[70:71], v[50:51]
K2_WRH:
    v_cvt_pk_bf16_f32 v44, v64, v65
    v_cvt_pk_bf16_f32 v45, v66, v67
    v_cvt_pk_bf16_f32 v46, v68, v69
    v_cvt_pk_bf16_f32 v47, v70, v71
    ds_write_b128 v54, v[44:47]
K2_NEXT:
    s_waitcnt lgkmcnt(0)
    v_readfirstlane_b32 s27, v60
    s_branch K2_ITEM
K2_P_START:
    v_mov_b32 v64, 0
    v_mov_b32 v65, 0
    v_mov_b32 v66, 0
    v_mov_b32 v67, 0
    v_mov_b32 v68, 0
    v_mov_b32 v69, 0
    v_mov_b32 v70, 0
    v_mov_b32 v71, 0
    s_cmp_eq_u32 s29, 0
    s_cbranch_scc1 K2_P_FLUSH
    v_cmpx_lt_u32 vcc, 0, v53
K2_P_S0:
    s_waitcnt lgkmcnt(0)
    v_pk_fma_f32 v[36:37], v[28:29], v[124:125], v[20:21] op_sel_hi:[1,0,1]
    v_pk_fma_f32 v[38:39], v[30:31], v[124:125], v[22:23] op_sel_hi:[1,0,1]
    v_pk_fma_f32 v[40:41], v[32:33], v[124:125], v[24:25] op_sel_hi:[1,0,1]
    v_pk_fma_f32 v[42:43], v[34:35], v[124:125], v[26:27] op_sel_hi:[1,0,1]
    ds_read_b32 v125, v52 offset:12
    s_waitcnt vmcnt(3)
    v_lshlrev_b32 v44, 16, v100
    v_lshlrev_b32 v45, 16, v101
    v_lshlrev_b32 v46, 16, v102
    v_lshlrev_b32 v47, 16, v103
    v_pk_add_f32 v[40:41], v[100:101], v[40:41]
    v_pk_add_f32 v[42:43], v[102:103], v[42:43]
    v_pk_add_f32 v[36:37], v[44:45], v[36:37]
    v_pk_add_f32 v[38:39], v[46:47], v[38:39]
    buffer_load_dwordx4 v[100:103], v[116:117], s[52:55], s32 idxen offen sc1
    ds_read_b32 v118, v52 offset:40
    s_add_u32 s28, s28, 1
    s_cmp_lt_i32 s28, s31
    s_cselect_b32 s54, 25000, 0
    s_cmp_ge_u32 s28, s30
    v_exp_f32 v48, v40
    v_exp_f32 v49, v41
    v_exp_f32 v50, v42
    v_exp_f32 v51, v43
    v_exp_f32 v44, v36
    v_exp_f32 v45, v37
    v_exp_f32 v46, v38
    v_exp_f32 v47, v39
    v_pk_add_f32 v[48:49], v[48:49], 1.0 op_sel_hi:[1,0]
    v_pk_add_f32 v[50:51], v[50:51], 1.0 op_sel_hi:[1,0]
    v_pk_add_f32 v[44:45], v[44:45], 1.0 op_sel_hi:[1,0]
    v_pk_add_f32 v[46:47], v[46:47], 1.0 op_sel_hi:[1,0]
    v_rcp_f32 v48, v48
    v_rcp_f32 v49, v49
    v_rcp_f32 v50, v50
    v_rcp_f32 v51, v51
    v_rcp_f32 v44, v44
    v_rcp_f32 v45, v45
    v_rcp_f32 v46, v46
    v_rcp_f32 v47, v47
    v_pk_fma_f32 v[68:69], v[40:41], v[48:49], v[68:69]
    v_pk_fma_f32 v[70:71], v[42:43], v[50:51], v[70:71]
    v_pk_fma_f32 v[64:65], v[36:37], v[44:45], v[64:65]
    v_pk_fma_f32 v[66:67], v[38:39], v[46:47], v[66:67]
    s_cbranch_scc1 K2_P_T0
K2_P_S1:
    s_waitcnt lgkmcnt(0)
    v_pk_fma_f32 v[36:37], v[28:29], v[124:125], v[20:21] op_sel:[0,1,0] op_sel_hi:[1,1,1]
    v_pk_fma_f32 v[38:39], v[30:31], v[124:125], v[22:23] op_sel:[0,1,0] op_sel_hi:[1,1,1]
    v_pk_fma_f32 v[40:41], v[32:33], v[124:125], v[24:25] op_sel:[0,1,0] op_sel_hi:[1,1,1]
    v_pk_fma_f32 v[42:43], v[34:35], v[124:125], v[26:27] op_sel:[0,1,0] op_sel_hi:[1,1,1]
    ds_read_b32 v124, v52 offset:20
    s_waitcnt vmcnt(3)
    v_lshlrev_b32 v44, 16, v104
    v_lshlrev_b32 v45, 16, v105
    v_lshlrev_b32 v46, 16, v106
    v_lshlrev_b32 v47, 16, v107
    v_pk_add_f32 v[40:41], v[104:105], v[40:41]
    v_pk_add_f32 v[42:43], v[106:107], v[42:43]
    v_pk_add_f32 v[36:37], v[44:45], v[36:37]
    v_pk_add_f32 v[38:39], v[46:47], v[38:39]
    buffer_load_dwordx4 v[104:107], v[118:119], s[52:55], s32 idxen offen sc1
    ds_read_b32 v120, v52 offset:48
    s_add_u32 s28, s28, 1
    s_cmp_lt_i32 s28, s31
    s_cselect_b32 s54, 25000, 0
    s_cmp_ge_u32 s28, s30
    v_exp_f32 v48, v40
    v_exp_f32 v49, v41
    v_exp_f32 v50, v42
    v_exp_f32 v51, v43
    v_exp_f32 v44, v36
    v_exp_f32 v45, v37
    v_exp_f32 v46, v38
    v_exp_f32 v47, v39
    v_pk_add_f32 v[48:49], v[48:49], 1.0 op_sel_hi:[1,0]
    v_pk_add_f32 v[50:51], v[50:51], 1.0 op_sel_hi:[1,0]
    v_pk_add_f32 v[44:45], v[44:45], 1.0 op_sel_hi:[1,0]
    v_pk_add_f32 v[46:47], v[46:47], 1.0 op_sel_hi:[1,0]
    v_rcp_f32 v48, v48
    v_rcp_f32 v49, v49
    v_rcp_f32 v50, v50
    v_rcp_f32 v51, v51
    v_rcp_f32 v44, v44
    v_rcp_f32 v45, v45
    v_rcp_f32 v46, v46
    v_rcp_f32 v47, v47
    v_pk_fma_f32 v[68:69], v[40:41], v[48:49], v[68:69]
    v_pk_fma_f32 v[70:71], v[42:43], v[50:51], v[70:71]
    v_pk_fma_f32 v[64:65], v[36:37], v[44:45], v[64:65]
    v_pk_fma_f32 v[66:67], v[38:39], v[46:47], v[66:67]
    s_cbranch_scc1 K2_P_T1
K2_P_S2:
    s_waitcnt lgkmcnt(0)
    v_pk_fma_f32 v[36:37], v[28:29], v[124:125], v[20:21] op_sel_hi:[1,0,1]
    v_pk_fma_f32 v[38:39], v[30:31], v[124:125], v[22:23] op_sel_hi:[1,0,1]
    v_pk_fma_f32 v[40:41], v[32:33], v[124:125], v[24:25] op_sel_hi:[1,0,1]
    v_pk_fma_f32 v[42:43], v[34:35], v[124:125], v[26:27] op_sel_hi:[1,0,1]
    ds_read_b32 v125, v52 offset:28
    s_waitcnt vmcnt(3)
    v_lshlrev_b32 v44, 16, v108
    v_lshlrev_b32 v45, 16, v109
    v_lshlrev_b32 v46, 16, v110
    v_lshlrev_b32 v47, 16, v111
    v_pk_add_f32 v[40:41], v[108:109], v[40:41]
    v_pk_add_f32 v[42:43], v[110:111], v[42:43]
    v_pk_add_f32 v[36:37], v[44:45], v[36:37]
    v_pk_add_f32 v[38:39], v[46:47], v[38:39]
    buffer_load_dwordx4 v[108:111], v[120:121], s[52:55], s32 idxen offen sc1
    ds_read_b32 v122, v52 offset:56
    s_add_u32 s28, s28, 1
    s_cmp_lt_i32 s28, s31
    s_cselect_b32 s54, 25000, 0
    s_cmp_ge_u32 s28, s30
    v_exp_f32 v48, v40
    v_exp_f32 v49, v41
    v_exp_f32 v50, v42
    v_exp_f32 v51, v43
    v_exp_f32 v44, v36
    v_exp_f32 v45, v37
    v_exp_f32 v46, v38
    v_exp_f32 v47, v39
    v_pk_add_f32 v[48:49], v[48:49], 1.0 op_sel_hi:[1,0]
    v_pk_add_f32 v[50:51], v[50:51], 1.0 op_sel_hi:[1,0]
    v_pk_add_f32 v[44:45], v[44:45], 1.0 op_sel_hi:[1,0]
    v_pk_add_f32 v[46:47], v[46:47], 1.0 op_sel_hi:[1,0]
    v_rcp_f32 v48, v48
    v_rcp_f32 v49, v49
    v_rcp_f32 v50, v50
    v_rcp_f32 v51, v51
    v_rcp_f32 v44, v44
    v_rcp_f32 v45, v45
    v_rcp_f32 v46, v46
    v_rcp_f32 v47, v47
    v_pk_fma_f32 v[68:69], v[40:41], v[48:49], v[68:69]
    v_pk_fma_f32 v[70:71], v[42:43], v[50:51], v[70:71]
    v_pk_fma_f32 v[64:65], v[36:37], v[44:45], v[64:65]
    v_pk_fma_f32 v[66:67], v[38:39], v[46:47], v[66:67]
    s_cbranch_scc1 K2_P_T2
K2_P_S3:
    s_waitcnt lgkmcnt(0)
    v_pk_fma_f32 v[36:37], v[28:29], v[124:125], v[20:21] op_sel:[0,1,0] op_sel_hi:[1,1,1]
    v_pk_fma_f32 v[38:39], v[30:31], v[124:125], v[22:23] op_sel:[0,1,0] op_sel_hi:[1,1,1]
    v_pk_fma_f32 v[40:41], v[32:33], v[124:125], v[24:25] op_sel:[0,1,0] op_sel_hi:[1,1,1]
    v_pk_fma_f32 v[42:43], v[34:35], v[124:125], v[26:27] op_sel:[0,1,0] op_sel_hi:[1,1,1]
    ds_read_b32 v124, v52 offset:36
    s_waitcnt vmcnt(3)
    v_lshlrev_b32 v44, 16, v112
    v_lshlrev_b32 v45, 16, v113
    v_lshlrev_b32 v46, 16, v114
    v_lshlrev_b32 v47, 16, v115
    v_pk_add_f32 v[40:41], v[112:113], v[40:41]
    v_pk_add_f32 v[42:43], v[114:115], v[42:43]
    v_pk_add_f32 v[36:37], v[44:45], v[36:37]
    v_pk_add_f32 v[38:39], v[46:47], v[38:39]
    buffer_load_dwordx4 v[112:115], v[122:123], s[52:55], s32 idxen offen sc1
    ds_read_b32 v116, v52 offset:64
    s_add_u32 s28, s28, 1
    s_cmp_lt_i32 s28, s31
    s_cselect_b32 s54, 25000, 0
    s_cmp_ge_u32 s28, s30
    v_exp_f32 v48, v40
    v_exp_f32 v49, v41
    v_exp_f32 v50, v42
    v_exp_f32 v51, v43
    v_exp_f32 v44, v36
    v_exp_f32 v45, v37
    v_exp_f32 v46, v38
    v_exp_f32 v47, v39
    v_pk_add_f32 v[48:49], v[48:49], 1.0 op_sel_hi:[1,0]
    v_pk_add_f32 v[50:51], v[50:51], 1.0 op_sel_hi:[1,0]
    v_pk_add_f32 v[44:45], v[44:45], 1.0 op_sel_hi:[1,0]
    v_pk_add_f32 v[46:47], v[46:47], 1.0 op_sel_hi:[1,0]
    v_rcp_f32 v48, v48
    v_rcp_f32 v49, v49
    v_rcp_f32 v50, v50
    v_rcp_f32 v51, v51
    v_rcp_f32 v44, v44
    v_rcp_f32 v45, v45
    v_rcp_f32 v46, v46
    v_rcp_f32 v47, v47
    v_pk_fma_f32 v[68:69], v[40:41], v[48:49], v[68:69]
    v_pk_fma_f32 v[70:71], v[42:43], v[50:51], v[70:71]
    v_pk_fma_f32 v[64:65], v[36:37], v[44:45], v[64:65]
    v_pk_fma_f32 v[66:67], v[38:39], v[46:47], v[66:67]
    v_add_u32 v52, 32, v52
    s_setprio 1
    s_cbranch_scc0 K2_P_S0
K2_P_T3:
    s_setprio 2
    s_cmp_ge_u32 s28, s29
    s_cbranch_scc1 K2_P_FLUSH
    v_cmpx_lt_u32 vcc, s28, v53
    s_branch K2_P_S0
K2_P_T0:
    s_setprio 2
    s_cmp_ge_u32 s28, s29
    s_cbranch_scc1 K2_P_FLUSH
    v_cmpx_lt_u32 vcc, s28, v53
    s_branch K2_P_S1
K2_P_T1:
    s_setprio 2
    s_cmp_ge_u32 s28, s29
    s_cbranch_scc1 K2_P_FLUSH
    v_cmpx_lt_u32 vcc, s28, v53
    s_branch K2_P_S2
K2_P_T2:
    s_setprio 2
    s_cmp_ge_u32 s28, s29
    s_cbranch_scc1 K2_P_FLUSH
    v_cmpx_lt_u32 vcc, s28, v53
    s_branch K2_P_S3
K2_P_FLUSH:
    s_mov_b64 exec, 1
    v_mov_b32 v60, 0
    v_mov_b32 v61, 1
    ds_add_rtn_u32 v60, v60, v61 offset:4432
    s_mov_b64 exec, -1
    s_cmp_le_u32 s69, 1
    s_cbranch_scc1 K2_WRH
    s_mul_i32 s24, s2, 104448
    s_add_u32 s24, s24, 33498368
    s_mov_b32 s64, s22
    s_mov_b32 s65, s23
    s_mov_b32 s66, 60293120
    s_mov_b32 s67, 0x00020000
    v_add_u32 v54, v54, v56
    s_cmp_eq_u32 s68, 0
    s_cbranch_scc1 K2_P_ST
    buffer_load_dwordx4 v[44:47], v54, s[64:67], s24 offen
    buffer_load_dwordx4 v[48:51], v54, s[64:67], s24 offen offset:16
    s_waitcnt vmcnt(0)
    v_pk_add_f32 v[64:65], v[64:65], v[44:45]
    v_pk_add_f32 v[66:67], v[66:67], v[46:47]
    v_pk_add_f32 v[68:69], v[68:69], v[48:49]
    v_pk_add_f32 v[70:71], v[70:71], v[50:51]
K2_P_ST:
    buffer_store_dwordx4 v[64:67], v54, s[64:67], s24 offen
    buffer_store_dwordx4 v[68:71], v54, s[64:67], s24 offen offset:16
    s_waitcnt vmcnt(0)
    s_branch K2_NEXT
K2_DONE:
    s_add_u32 s68, s68, 1
    s_cmp_ge_u32 s68, s69
    s_cbranch_scc1 K2_FINAL
    s_waitcnt vmcnt(0)
    s_add_u32 s70, s70, 192
    v_subrev_u32 v127, 24, v127
    v_cmp_lt_i32 s[72:73], 0, v127
    v_cmp_lt_i32 s[74:75], 1, v127
    v_cmp_lt_i32 s[76:77], 8, v127
    v_cmp_lt_i32 s[78:79], 9, v127
    v_cmp_lt_i32 s[80:81], 16, v127
    v_cmp_lt_i32 s[82:83], 17, v127
    s_mov_b64 exec, s[72:73]
    buffer_load_dwordx4 v[100:103], v126, s[48:51], s70 offen offset:0 sc1
    s_mov_b64 exec, s[76:77]
    buffer_load_dwordx4 v[104:107], v126, s[48:51], s70 offen offset:64 sc1
    s_mov_b64 exec, s[80:81]
    buffer_load_dwordx4 v[108:111], v126, s[48:51], s70 offen offset:128 sc1
    s_mov_b64 exec, -1
    s_barrier
    v_mov_b32 v4, 0
    v_lshlrev_b32 v5, 2, v0
    v_cmp_gt_u32 vcc, 192, v0
    s_mov_b64 exec, vcc
    ds_write_b32 v5, v4 offset:0
    s_mov_b64 exec, 1
    v_mov_b32 v5, 4416
    v_mov_b32 v6, 16
    ds_write_b32 v5, v6 offset:16
    s_mov_b64 exec, -1
    s_waitcnt lgkmcnt(0)
    s_barrier
    s_branch K2_BATCH
K2_FINAL:
    s_waitcnt vmcnt(0)
    s_and_b32 s24, s3, 3
    s_lshl_b32 s25, s24, 14
    s_add_u32 s25, s25, 33095680
    v_lshlrev_b32 v4, 4, v1
    buffer_load_dwordx4 v[32:35], v4, s[48:51], s25 offen offset:0 sc1
    buffer_load_dwordx4 v[36:39], v4, s[48:51], s25 offen offset:1024 sc1
    buffer_load_dwordx4 v[40:43], v4, s[48:51], s25 offen offset:2048 sc1
    buffer_load_dwordx4 v[44:47], v4, s[48:51], s25 offen offset:3072 sc1
    s_add_u32 s25, s25, 4096
    buffer_load_dwordx4 v[48:51], v4, s[48:51], s25 offen offset:0 sc1
    buffer_load_dwordx4 v[52:55], v4, s[48:51], s25 offen offset:1024 sc1
    buffer_load_dwordx4 v[56:59], v4, s[48:51], s25 offen offset:2048 sc1
    buffer_load_dwordx4 v[60:63], v4, s[48:51], s25 offen offset:3072 sc1
    s_add_u32 s25, s25, 4096
    buffer_load_dwordx4 v[64:67], v4, s[48:51], s25 offen offset:0 sc1
    buffer_load_dwordx4 v[68:71], v4, s[48:51], s25 offen offset:1024 sc1
    buffer_load_dwordx4 v[72:75], v4, s[48:51], s25 offen offset:2048 sc1
    buffer_load_dwordx4 v[76:79], v4, s[48:51], s25 offen offset:3072 sc1
    s_add_u32 s25, s25, 4096
    buffer_load_dwordx4 v[80:83], v4, s[48:51], s25 offen offset:0 sc1
    buffer_load_dwordx4 v[84:87], v4, s[48:51], s25 offen offset:1024 sc1
    buffer_load_dwordx4 v[88:91], v4, s[48:51], s25 offen offset:2048 sc1
    buffer_load_dwordx4 v[92:95], v4, s[48:51], s25 offen offset:3072 sc1
    s_mov_b32 s60, s18
    s_mov_b32 s61, s19
    s_mov_b32 s62, 256
    s_mov_b32 s63, 0x00020000
    s_mov_b32 s56, s20
    s_mov_b32 s57, s21
    s_mov_b32 s58, 6400000
    s_mov_b32 s59, 0x00020000
    s_lshl_b32 s24, s24, 6
    v_lshlrev_b32 v5, 4, v3
    buffer_load_dwordx4 v[8:11], v5, s[60:63], s24 offen
    s_lshr_b32 s27, s3, 2
    s_lshl_b32 s27, s27, 4
    v_add_u32 v6, s27, v2
    v_mul_u32_u24 v7, 1040, v6
    v_add_u32 v7, v7, v5
    v_add_u32 v7, 56064, v7
    v_lshlrev_b32 v20, 2, v6
    v_add_u32 v21, s26, v6
    v_lshl_add_u32 v21, v21, 8, v5
    s_mov_b32 s34, 0xbf317218
    s_barrier
    s_cmp_le_u32 s69, 1
    s_cbranch_scc1 K2_GEMM2
    s_mul_i32 s28, s2, 104448
    s_add_u32 s28, s28, 33554432
    s_mov_b32 s64, s22
    s_mov_b32 s65, s23
    s_mov_b32 s66, 60293120
    s_mov_b32 s67, 0x00020000
    v_and_b32 v22, 1, v3
    v_lshlrev_b32 v22, 9, v22
    v_lshl_add_u32 v22, v2, 4, v22
    v_lshl_add_u32 v23, v2, 4, v22
    s_mov_b32 s29, s3
K2_CONV:
    s_mul_i32 s30, s29, 1040
    s_add_u32 s31, s30, s28
    buffer_load_dwordx4 v[100:103], v23, s[64:67], s31 offen
    buffer_load_dwordx4 v[104:107], v23, s[64:67], s31 offen offset:16
    s_add_u32 s30, s30, 56064
    v_add_u32 v24, s30, v22
    s_waitcnt vmcnt(0)
    v_cvt_pk_bf16_f32 v100, v100, v101
    v_cvt_pk_bf16_f32 v101, v102, v103
    v_cvt_pk_bf16_f32 v102, v104, v105
    v_cvt_pk_bf16_f32 v103, v106, v107
    ds_write_b128 v24, v[100:103]
    s_add_u32 s29, s29, 16
    s_cmp_lt_u32 s29, 98
    s_cbranch_scc1 K2_CONV
    s_waitcnt lgkmcnt(0)
    s_barrier
K2_GEMM2:
    ds_read_b32 v22, v20 offset:768
    ds_read_b128 v[96:99], v7 offset:0
    ds_read_b128 v[100:103], v7 offset:64
    ds_read_b128 v[104:107], v7 offset:128
    ds_read_b128 v[108:111], v7 offset:192
    ds_read_b128 v[112:115], v7 offset:512
    ds_read_b128 v[116:119], v7 offset:576
    ds_read_b128 v[120:123], v7 offset:640
    ds_read_b128 v[124:127], v7 offset:704
    s_waitcnt vmcnt(0)
    v_lshlrev_b32 v12, 16, v8
    v_and_b32 v13, 0xffff0000, v8
    v_lshlrev_b32 v14, 16, v9
    v_and_b32 v15, 0xffff0000, v9
    v_lshlrev_b32 v16, 16, v10
    v_and_b32 v17, 0xffff0000, v10
    v_lshlrev_b32 v18, 16, v11
    v_and_b32 v19, 0xffff0000, v11
    s_waitcnt lgkmcnt(7)
    v_mfma_f32_16x16x32_bf16 v[24:27], v[32:35], v[96:99], 0
    v_mfma_f32_16x16x32_bf16 v[28:31], v[64:67], v[96:99], 0
    s_waitcnt lgkmcnt(6)
    v_mfma_f32_16x16x32_bf16 v[24:27], v[36:39], v[100:103], v[24:27]
    v_mfma_f32_16x16x32_bf16 v[28:31], v[68:71], v[100:103], v[28:31]
    s_waitcnt lgkmcnt(5)
    v_mfma_f32_16x16x32_bf16 v[24:27], v[40:43], v[104:107], v[24:27]
    v_mfma_f32_16x16x32_bf16 v[28:31], v[72:75], v[104:107], v[28:31]
    s_waitcnt lgkmcnt(4)
    v_mfma_f32_16x16x32_bf16 v[24:27], v[44:47], v[108:111], v[24:27]
    v_mfma_f32_16x16x32_bf16 v[28:31], v[76:79], v[108:111], v[28:31]
    s_waitcnt lgkmcnt(3)
    v_mfma_f32_16x16x32_bf16 v[24:27], v[48:51], v[112:115], v[24:27]
    v_mfma_f32_16x16x32_bf16 v[28:31], v[80:83], v[112:115], v[28:31]
    s_waitcnt lgkmcnt(2)
    v_mfma_f32_16x16x32_bf16 v[24:27], v[52:55], v[116:119], v[24:27]
    v_mfma_f32_16x16x32_bf16 v[28:31], v[84:87], v[116:119], v[28:31]
    s_waitcnt lgkmcnt(1)
    v_mfma_f32_16x16x32_bf16 v[24:27], v[56:59], v[120:123], v[24:27]
    v_mfma_f32_16x16x32_bf16 v[28:31], v[88:91], v[120:123], v[28:31]
    s_waitcnt lgkmcnt(0)
    v_mfma_f32_16x16x32_bf16 v[24:27], v[60:63], v[124:127], v[24:27]
    v_mfma_f32_16x16x32_bf16 v[28:31], v[92:95], v[124:127], v[28:31]
    v_cvt_f32_u32 v22, v22
    v_cmp_gt_u32 vcc, 98, v6
    s_nop 5
    v_mul_f32 v24, s34, v24
    v_mul_f32 v25, s34, v25
    v_mul_f32 v26, s34, v26
    v_mul_f32 v27, s34, v27
    v_mul_f32 v28, s34, v28
    v_mul_f32 v29, s34, v29
    v_mul_f32 v30, s34, v30
    v_mul_f32 v31, s34, v31
    v_fmac_f32 v24, v22, v12
    v_fmac_f32 v25, v22, v13
    v_fmac_f32 v26, v22, v14
    v_fmac_f32 v27, v22, v15
    v_fmac_f32 v28, v22, v16
    v_fmac_f32 v29, v22, v17
    v_fmac_f32 v30, v22, v18
    v_fmac_f32 v31, v22, v19
    v_cvt_pk_bf16_f32 v96, v24, v25
    v_cvt_pk_bf16_f32 v97, v26, v27
    v_cvt_pk_bf16_f32 v98, v28, v29
    v_cvt_pk_bf16_f32 v99, v30, v31
    s_mov_b64 exec, vcc
    buffer_store_dwordx4 v[96:99], v21, s[56:59], s24 offen sc1
    s_mov_b64 exec, -1
    s_nop 1
    s_cmp_ge_u32 s3, 12
    s_cbranch_scc1 K2_FIN
    v_add_u32 v7, 66560, v7
    v_add_u32 v21, 16384, v21
    ds_read_b32 v22, v20 offset:1024
    ds_read_b128 v[96:99], v7 offset:0
    ds_read_b128 v[100:103], v7 offset:64
    ds_read_b128 v[104:107], v7 offset:128
    ds_read_b128 v[108:111], v7 offset:192
    ds_read_b128 v[112:115], v7 offset:512
    ds_read_b128 v[116:119], v7 offset:576
    ds_read_b128 v[120:123], v7 offset:640
    ds_read_b128 v[124:127], v7 offset:704
    s_waitcnt lgkmcnt(7)
    v_mfma_f32_16x16x32_bf16 v[24:27], v[32:35], v[96:99], 0
    v_mfma_f32_16x16x32_bf16 v[28:31], v[64:67], v[96:99], 0
    s_waitcnt lgkmcnt(6)
    v_mfma_f32_16x16x32_bf16 v[24:27], v[36:39], v[100:103], v[24:27]
    v_mfma_f32_16x16x32_bf16 v[28:31], v[68:71], v[100:103], v[28:31]
    s_waitcnt lgkmcnt(5)
    v_mfma_f32_16x16x32_bf16 v[24:27], v[40:43], v[104:107], v[24:27]
    v_mfma_f32_16x16x32_bf16 v[28:31], v[72:75], v[104:107], v[28:31]
    s_waitcnt lgkmcnt(4)
    v_mfma_f32_16x16x32_bf16 v[24:27], v[44:47], v[108:111], v[24:27]
    v_mfma_f32_16x16x32_bf16 v[28:31], v[76:79], v[108:111], v[28:31]
    s_waitcnt lgkmcnt(3)
    v_mfma_f32_16x16x32_bf16 v[24:27], v[48:51], v[112:115], v[24:27]
    v_mfma_f32_16x16x32_bf16 v[28:31], v[80:83], v[112:115], v[28:31]
    s_waitcnt lgkmcnt(2)
    v_mfma_f32_16x16x32_bf16 v[24:27], v[52:55], v[116:119], v[24:27]
    v_mfma_f32_16x16x32_bf16 v[28:31], v[84:87], v[116:119], v[28:31]
    s_waitcnt lgkmcnt(1)
    v_mfma_f32_16x16x32_bf16 v[24:27], v[56:59], v[120:123], v[24:27]
    v_mfma_f32_16x16x32_bf16 v[28:31], v[88:91], v[120:123], v[28:31]
    s_waitcnt lgkmcnt(0)
    v_mfma_f32_16x16x32_bf16 v[24:27], v[60:63], v[124:127], v[24:27]
    v_mfma_f32_16x16x32_bf16 v[28:31], v[92:95], v[124:127], v[28:31]
    v_cvt_f32_u32 v22, v22
    v_cmp_gt_u32 vcc, 34, v6
    s_nop 5
    v_mul_f32 v24, s34, v24
    v_mul_f32 v25, s34, v25
    v_mul_f32 v26, s34, v26
    v_mul_f32 v27, s34, v27
    v_mul_f32 v28, s34, v28
    v_mul_f32 v29, s34, v29
    v_mul_f32 v30, s34, v30
    v_mul_f32 v31, s34, v31
    v_fmac_f32 v24, v22, v12
    v_fmac_f32 v25, v22, v13
    v_fmac_f32 v26, v22, v14
    v_fmac_f32 v27, v22, v15
    v_fmac_f32 v28, v22, v16
    v_fmac_f32 v29, v22, v17
    v_fmac_f32 v30, v22, v18
    v_fmac_f32 v31, v22, v19
    v_cvt_pk_bf16_f32 v96, v24, v25
    v_cvt_pk_bf16_f32 v97, v26, v27
    v_cvt_pk_bf16_f32 v98, v28, v29
    v_cvt_pk_bf16_f32 v99, v30, v31
    s_mov_b64 exec, vcc
    buffer_store_dwordx4 v[96:99], v21, s[56:59], s24 offen sc1
    s_mov_b64 exec, -1
K2_FIN:
K2_END:
    s_endpgm
.section .rodata,"a"
.p2align 6
.amdhsa_kernel gather_scatter__edge_featured_mpnn_mpnn__graph_kernel
  .amdhsa_next_free_vgpr 128
  .amdhsa_next_free_sgpr 102
  .amdhsa_accum_offset 128
  .amdhsa_group_segment_fixed_size 0
  .amdhsa_kernarg_size 88
  .amdhsa_user_sgpr_count 2
  .amdhsa_user_sgpr_kernarg_segment_ptr 1
  .amdhsa_system_sgpr_workgroup_id_x 1
.end_amdhsa_kernel
```
